```python
import torch

def _softmax(x, axis=-1):
    return torch.softmax(x, dim=axis)
def _gelu(x):
    return torch.nn.functional.gelu(x, approximate="tanh")
def _silu(x):
    return torch.nn.functional.silu(x)
def _sigmoid(x):
    return torch.sigmoid(x)
def _layernorm(x, axis=-1, eps=1e-5):
    m = x.mean(dim=axis, keepdim=True)
    v = x.var(dim=axis, keepdim=True, unbiased=False)
    return (x - m) / torch.sqrt(v + eps)
def _scatter_add(tgt, idx, src, axis=0):
    return tgt.clone().index_add_(axis, idx, src)
def _segment_sum(src, seg, n):
    out = torch.zeros((n,) + src.shape[1:], dtype=src.dtype)
    return out.index_add_(0, seg, src)
def _pad(x, pw):
    flat = tuple(v for pair in reversed(pw) for v in pair)
    return torch.nn.functional.pad(x, flat)

kernel_name = 'recurrent_scan__gqa_block_cached__mixer_channel_mlp__decode'

def setup_inputs():

    _w = (lambda a: (lambda t: t.to(torch.bfloat16) if t.is_floating_point() else t)(torch.as_tensor(a)))
    def _A_setup():
        B, Sq, D = 2, 1, 512
        Hq, Hkv, Sk, Dh = 32, 8, 32768, 128
        assert Hq % Hkv == 0, (Hq, Hkv)
        return {
            "x": _w((lambda *s: torch.randn(*s, dtype=torch.bfloat16) * 0.1)(B, Sq, D)),
            "k_cache": _w((lambda *s: torch.randn(*s, dtype=torch.bfloat16) * 0.8)(B, Hkv, Sk, Dh)),
            "v_cache": _w((lambda *s: torch.randn(*s, dtype=torch.bfloat16) * 3.2)(B, Hkv, Sk, Dh)),
            "wq": _w((lambda *s: torch.randn(*s, dtype=torch.bfloat16) * 0.8)(D, Hq * Dh) * (D ** -0.5)),
            "wo": _w((lambda *s: torch.randn(*s, dtype=torch.bfloat16) * 3.2)(Hq * Dh, D) * ((Hq * Dh) ** -0.5)),
        }
    _A_in = _A_setup()

    def _B_setup():
        B, S, D, F = 2, 1, 512, 1792
        return {
            "x": _w((lambda *s: torch.randn(*s, dtype=torch.bfloat16) * 0.1)(B, S, D)),
            "w1": _w((lambda *s: torch.randn(*s, dtype=torch.bfloat16) * 3.2)(D, F) * (D ** -0.5)),
            "b1": _w((lambda *s: torch.randn(*s, dtype=torch.bfloat16) * 3.2)(F)),
            "w2": _w((lambda *s: torch.randn(*s, dtype=torch.bfloat16) * 3.2)(F, D) * (F ** -0.5)),
            "b2": _w((lambda *s: torch.randn(*s, dtype=torch.bfloat16) * 3.2)(D)),
        }
    _B_in = _B_setup()

    return {
        "A_x": _A_in["x"],
        "A_k_cache": _A_in["k_cache"],
        "A_v_cache": _A_in["v_cache"],
        "A_wq": _A_in["wq"],
        "A_wo": _A_in["wo"],
        "B_x": _B_in["x"],
        "B_w1": _B_in["w1"],
        "B_b1": _B_in["b1"],
        "B_w2": _B_in["w2"],
        "B_b2": _B_in["b2"],
    }

def reference(A_x, A_k_cache, A_v_cache, A_wq, A_wo, B_x, B_w1, B_b1, B_w2, B_b2):
    def _A_ref(x, k_cache, v_cache, wq, wo):
        B, Sq, D = x.shape
        Hq, Dh = 32, 128
        Hkv = k_cache.shape[1]
        rep = Hq // Hkv
        q = (lambda x, *d: x.permute(*d))((x @ wq).reshape(B, Sq, Hq, Dh), 0, 2, 1, 3)
        k = (lambda x, n, axis: torch.repeat_interleave(x, n, dim=axis))(k_cache, rep, axis=1)
        v = (lambda x, n, axis: torch.repeat_interleave(x, n, dim=axis))(v_cache, rep, axis=1)
        scores = torch.einsum("bhqd,bhkd->bhqk", q, k) * (Dh ** -0.5)
        p = _softmax(scores, axis=-1)
        o = torch.einsum("bhqk,bhkd->bhqd", p, v)
        return (lambda x, *d: x.permute(*d))(o, 0, 2, 1, 3).reshape(B, Sq, Hq * Dh) @ wo

    def _B_ref(x, w1, b1, w2, b2):
        y = _layernorm(x, axis=-1)
        h = _gelu(torch.einsum("bsd,df->bsf", y, w1) + b1)
        return torch.einsum("bsf,fd->bsd", h, w2) + b2

    x = A_x
    xn = _layernorm(x, axis=-1)
    s = _A_ref(xn, A_k_cache, A_v_cache, A_wq, A_wo)
    g = _silu(_B_ref(xn, B_w1, B_b1, B_w2, B_b2))
    return x + s * g
```

```asm
; @launch grid=(256,1,1) block=(512,1,1) lds=38144
.amdgcn_target "amdgcn-amd-amdhsa--gfx950"
.text
.globl recurrent_scan__gqa_block_cached__mixer_channel_mlp__decode_kernel
.p2align 8
.type recurrent_scan__gqa_block_cached__mixer_channel_mlp__decode_kernel,@function
recurrent_scan__gqa_block_cached__mixer_channel_mlp__decode_kernel:
    s_cmp_ge_u32 s2, 256
    s_cbranch_scc1 L_end
    s_load_dwordx16 s[72:87], s[0:1], 0
    s_load_dwordx8 s[88:95], s[0:1], 64
    s_load_dwordx2 s[48:49], s[0:1], 96
    v_lshrrev_b32 v1, 6, v0
    v_and_b32 v0, 63, v0
    s_bfe_u32 s4, s2, 0x40003
    v_readfirstlane_b32 s3, v1
    s_lshl_b32 s4, s4, 23
    s_mov_b32 s29, 8388608
    s_mov_b32 s42, s29
    s_mov_b32 s43, 0x00020000
    s_mov_b32 s46, s29
    s_mov_b32 s47, 0x00020000
    s_mov_b32 s50, 3145728
    s_mov_b32 s51, 0x00020000
    s_mov_b32 s32, 0x3e0293ee
    s_mov_b32 s33, 0xbe0293ee
    s_mov_b32 s34, 0x05040100
    s_mov_b32 s35, 0x07060302
    s_mov_b32 s70, 2048
    s_mov_b32 s71, 0x00020000
    v_lshlrev_b32 v100, 2, v0
    v_mov_b32 v101, 0
    s_mov_b32 s5, 36864
    v_writelane_b32 v101, s5, 0
    s_mov_b64 exec, 7
    ds_write_b32 v100, v101 offset:33024
    s_mov_b64 exec, -1
    s_waitcnt lgkmcnt(0)
    s_add_u32 s40, s74, s4
    s_addc_u32 s41, s75, 0
    s_add_u32 s44, s76, s4
    s_addc_u32 s45, s77, 0
    s_mov_b64 s[68:69], s[92:93]
    s_cmp_ge_u32 s3, 4
    s_cbranch_scc1 L_helper
    s_cmp_eq_u32 s3, 0
    s_cbranch_scc1 L_w0
    s_mov_b32 s31, 1
    s_cmp_ge_u32 s2, 92
    s_cbranch_scc1 L_st_nb
    s_barrier
    s_mov_b32 s31, 2
L_st_nb:
L_stream:
    v_and_b32 v5, 15, v0
    v_lshrrev_b32 v6, 4, v0
    v_lshlrev_b32 v3, 10, v6
    v_lshl_add_u32 v3, v5, 4, v3
    v_add_u32 v4, 4096, v3
    s_sub_u32 s4, s3, 1
    s_lshl_b32 s4, s4, 12
    v_mov_b32 v8, s4
    v_add_u32 v9, 12288, v8
    v_add_u32 v10, 24576, v8
    s_cmp_lg_u32 s31, 0
    s_cbranch_scc1 L_st_hp
    s_mov_b64 exec, 1
    ds_add_rtn_u32 v8, v3, v4 offset:33024
    v_mov_b32 v9, 0x400000
    v_mov_b32 v10, 0x400000
    s_cmp_ge_u32 s3, 4
    s_cbranch_scc1 L_st_hp
    ds_add_rtn_u32 v9, v3, v4 offset:33024
    ds_add_rtn_u32 v10, v3, v4 offset:33024
L_st_hp:
    s_mov_b64 exec, -1
    s_and_b32 s4, s2, 7
    s_lshl_b32 s6, s4, 20
    s_cmp_ge_u32 s2, 128
    s_cselect_b32 s5, 507904, 0
    s_add_u32 s6, s6, s5
    s_mov_b32 s29, 475136
    s_cmp_ge_u32 s2, 128
    s_cselect_b32 s29, 507904, s29
    s_add_u32 s29, s29, s6
    s_bfe_u32 s4, s2, 0x40003
    s_mul_i32 s97, s4, 4096
    s_add_u32 s97, s97, 1835008
    s_mov_b32 s96, 0
    s_setprio 0
    s_cmp_lt_u32 s3, 4
    s_cbranch_scc1 L_st_prio
    s_setprio 3
L_st_prio:
    v_lshlrev_b32 v1, 8, v5
    v_lshl_add_u32 v1, v6, 4, v1
    v_add_u32 v2, 4096, v1
    v_and_b32 v7, 3, v5
    v_lshlrev_b32 v7, 8, v7
    v_lshl_add_u32 v7, v6, 4, v7
    v_mov_b32 v5, 0xff800000
    v_mov_b32 v6, 0
    s_mov_b32 s27, 0
    s_mov_b32 s28, 0
    s_waitcnt lgkmcnt(0)
    v_readfirstlane_b32 s24, v8
    v_readfirstlane_b32 s25, v9
    v_readfirstlane_b32 s26, v10
    s_load_dword s39, s[48:49], 4
    s_lshl1_add_u32 s24, s24, s6
    s_lshl1_add_u32 s25, s25, s6
    s_lshl1_add_u32 s26, s26, s6
    s_cmp_ge_u32 s24, s29
    s_cbranch_scc1 L_st_nowork
    buffer_load_dwordx4 v[64:67], v1, s[40:43], s24 offen offset:0 nt
    buffer_load_dwordx4 v[68:71], v1, s[40:43], s24 offen offset:64 nt
    buffer_load_dwordx4 v[72:75], v1, s[40:43], s24 offen offset:128 nt
    buffer_load_dwordx4 v[76:79], v1, s[40:43], s24 offen offset:192 nt
    s_waitcnt vmcnt(8)
    buffer_load_dwordx4 v[80:83], v2, s[40:43], s24 offen offset:0 nt
    buffer_load_dwordx4 v[84:87], v2, s[40:43], s24 offen offset:64 nt
    buffer_load_dwordx4 v[88:91], v2, s[40:43], s24 offen offset:128 nt
    buffer_load_dwordx4 v[92:95], v2, s[40:43], s24 offen offset:192 nt
    v_mov_b32 v32, 0
    v_mov_b32 v33, 0
    v_mov_b32 v34, 0
    v_mov_b32 v35, 0
    v_mov_b32 v36, 0
    v_mov_b32 v37, 0
    v_mov_b32 v38, 0
    v_mov_b32 v39, 0
    v_mov_b32 v40, 0
    v_mov_b32 v41, 0
    v_mov_b32 v42, 0
    v_mov_b32 v43, 0
    v_mov_b32 v44, 0
    v_mov_b32 v45, 0
    v_mov_b32 v46, 0
    v_mov_b32 v47, 0
    v_mov_b32 v48, 0
    v_mov_b32 v49, 0
    v_mov_b32 v50, 0
    v_mov_b32 v51, 0
    v_mov_b32 v52, 0
    v_mov_b32 v53, 0
    v_mov_b32 v54, 0
    v_mov_b32 v55, 0
    v_mov_b32 v56, 0
    v_mov_b32 v57, 0
    v_mov_b32 v58, 0
    v_mov_b32 v59, 0
    v_mov_b32 v60, 0
    v_mov_b32 v61, 0
    v_mov_b32 v62, 0
    v_mov_b32 v63, 0
    s_waitcnt vmcnt(8)
    buffer_load_dwordx4 v[96:99], v3, s[44:47], s24 offen offset:0 nt
    buffer_load_dwordx4 v[100:103], v3, s[44:47], s24 offen offset:256 nt
    buffer_load_dwordx4 v[104:107], v3, s[44:47], s24 offen offset:512 nt
    buffer_load_dwordx4 v[108:111], v3, s[44:47], s24 offen offset:768 nt
    s_cmp_lg_u32 s31, 1
    s_cbranch_scc1 L_st_nb2
    s_barrier
L_st_nb2:
    s_waitcnt vmcnt(8)
    buffer_load_dwordx4 v[112:115], v4, s[44:47], s24 offen offset:0 nt
    buffer_load_dwordx4 v[116:119], v4, s[44:47], s24 offen offset:256 nt
    buffer_load_dwordx4 v[120:123], v4, s[44:47], s24 offen offset:512 nt
    buffer_load_dwordx4 v[124:127], v4, s[44:47], s24 offen offset:768 nt
    s_mov_b32 s27, 1
    s_cmp_ge_u32 s25, s29
    s_cbranch_scc1 L_st_pro_done
    s_waitcnt vmcnt(8)
    buffer_load_dwordx4 v[128:131], v1, s[40:43], s25 offen offset:0 nt
    buffer_load_dwordx4 v[132:135], v1, s[40:43], s25 offen offset:64 nt
    buffer_load_dwordx4 v[136:139], v1, s[40:43], s25 offen offset:128 nt
    buffer_load_dwordx4 v[140:143], v1, s[40:43], s25 offen offset:192 nt
    s_waitcnt vmcnt(8)
    buffer_load_dwordx4 v[144:147], v2, s[40:43], s25 offen offset:0 nt
    buffer_load_dwordx4 v[148:151], v2, s[40:43], s25 offen offset:64 nt
    buffer_load_dwordx4 v[152:155], v2, s[40:43], s25 offen offset:128 nt
    buffer_load_dwordx4 v[156:159], v2, s[40:43], s25 offen offset:192 nt
    s_waitcnt vmcnt(8)
    buffer_load_dwordx4 v[160:163], v3, s[44:47], s25 offen offset:0 nt
    buffer_load_dwordx4 v[164:167], v3, s[44:47], s25 offen offset:256 nt
    buffer_load_dwordx4 v[168:171], v3, s[44:47], s25 offen offset:512 nt
    buffer_load_dwordx4 v[172:175], v3, s[44:47], s25 offen offset:768 nt
    s_waitcnt vmcnt(8)
    buffer_load_dwordx4 v[176:179], v4, s[44:47], s25 offen offset:0 nt
    buffer_load_dwordx4 v[180:183], v4, s[44:47], s25 offen offset:256 nt
    buffer_load_dwordx4 v[184:187], v4, s[44:47], s25 offen offset:512 nt
    buffer_load_dwordx4 v[188:191], v4, s[44:47], s25 offen offset:768 nt
    s_mov_b32 s27, 2
    s_cmp_ge_u32 s26, s29
    s_cbranch_scc1 L_st_pro_done
    s_waitcnt vmcnt(8)
    buffer_load_dwordx4 v[192:195], v1, s[40:43], s26 offen offset:0 nt
    buffer_load_dwordx4 v[196:199], v1, s[40:43], s26 offen offset:64 nt
    buffer_load_dwordx4 v[200:203], v1, s[40:43], s26 offen offset:128 nt
    buffer_load_dwordx4 v[204:207], v1, s[40:43], s26 offen offset:192 nt
    s_waitcnt vmcnt(8)
    buffer_load_dwordx4 v[208:211], v2, s[40:43], s26 offen offset:0 nt
    buffer_load_dwordx4 v[212:215], v2, s[40:43], s26 offen offset:64 nt
    buffer_load_dwordx4 v[216:219], v2, s[40:43], s26 offen offset:128 nt
    buffer_load_dwordx4 v[220:223], v2, s[40:43], s26 offen offset:192 nt
    s_waitcnt vmcnt(8)
    buffer_load_dwordx4 v[224:227], v3, s[44:47], s26 offen offset:0 nt
    buffer_load_dwordx4 v[228:231], v3, s[44:47], s26 offen offset:256 nt
    buffer_load_dwordx4 v[232:235], v3, s[44:47], s26 offen offset:512 nt
    buffer_load_dwordx4 v[236:239], v3, s[44:47], s26 offen offset:768 nt
    s_waitcnt vmcnt(8)
    buffer_load_dwordx4 v[240:243], v4, s[44:47], s26 offen offset:0 nt
    buffer_load_dwordx4 v[244:247], v4, s[44:47], s26 offen offset:256 nt
    buffer_load_dwordx4 v[248:251], v4, s[44:47], s26 offen offset:512 nt
    buffer_load_dwordx4 v[252:255], v4, s[44:47], s26 offen offset:768 nt
    s_mov_b32 s27, 3
L_st_pro_done:
    s_mov_b32 s30, 65536
    s_mov_b64 exec, 1
L_qflag:
    ds_read_b32 v8, v3 offset:33032
    s_waitcnt lgkmcnt(0)
    v_readfirstlane_b32 s4, v8
    s_cmp_lg_u32 s4, 0
    s_cbranch_scc1 L_qflag_done
    s_sleep 1
    s_sub_u32 s30, s30, 1
    s_cmp_lg_u32 s30, 0
    s_cbranch_scc1 L_qflag
L_qflag_done:
    s_mov_b64 exec, -1
    ds_read_b128 v[16:19], v7 offset:33280
    ds_read_b128 v[20:23], v7 offset:33344
    ds_read_b128 v[24:27], v7 offset:33408
    ds_read_b128 v[28:31], v7 offset:33472
    s_waitcnt lgkmcnt(0)
L_st_loop:
    s_cmp_eq_u32 s28, 0
    s_cbranch_scc1 L_st_nova0
    s_waitcnt vmcnt(8)
    s_cmp_eq_u32 s96, 0
    s_cbranch_scc1 L_st_nog0
    v_mov_b32 v7, 1
    s_mov_b64 exec, 1
    buffer_atomic_add v7, off, s[48:51], s97 sc0
    s_mov_b64 exec, -1
L_st_nog0:
    buffer_load_dwordx4 v[224:227], v3, s[44:47], s26 offen offset:0 nt
    buffer_load_dwordx4 v[228:231], v3, s[44:47], s26 offen offset:256 nt
    buffer_load_dwordx4 v[232:235], v3, s[44:47], s26 offen offset:512 nt
    buffer_load_dwordx4 v[236:239], v3, s[44:47], s26 offen offset:768 nt
L_st_go0:
    v_mfma_f32_16x16x32_bf16 v[8:11], v[64:67], v[16:19], 0
    v_mfma_f32_16x16x32_bf16 v[12:15], v[80:83], v[16:19], 0
    v_mfma_f32_16x16x32_bf16 v[8:11], v[68:71], v[20:23], v[8:11]
    v_mfma_f32_16x16x32_bf16 v[12:15], v[84:87], v[20:23], v[12:15]
    v_mfma_f32_16x16x32_bf16 v[8:11], v[72:75], v[24:27], v[8:11]
    v_mfma_f32_16x16x32_bf16 v[12:15], v[88:91], v[24:27], v[12:15]
    v_mfma_f32_16x16x32_bf16 v[8:11], v[76:79], v[28:31], v[8:11]
    v_mfma_f32_16x16x32_bf16 v[12:15], v[92:95], v[28:31], v[12:15]
    s_nop 6
    v_max3_f32 v92, v8, v9, v10
    v_max3_f32 v93, v12, v13, v14
    v_max3_f32 v92, v92, v11, v5
    v_max3_f32 v92, v92, v93, v15
    v_mov_b32 v93, v92
    s_nop 1
    v_permlane32_swap_b32 v92, v93
    v_max_f32 v92, v92, v93
    v_mov_b32 v93, v92
    s_nop 1
    v_permlane16_swap_b32 v92, v93
    v_max_f32 v92, v92, v93
    v_sub_f32 v93, v5, v92
    v_mul_f32 v95, s33, v92
    v_mul_f32 v93, s32, v93
    v_mov_b32 v5, v92
    v_exp_f32 v94, v93
    v_fma_f32 v8, v8, s32, v95
    v_fma_f32 v9, v9, s32, v95
    v_fma_f32 v10, v10, s32, v95
    v_fma_f32 v11, v11, s32, v95
    v_fma_f32 v12, v12, s32, v95
    v_fma_f32 v13, v13, s32, v95
    v_fma_f32 v14, v14, s32, v95
    v_fma_f32 v15, v15, s32, v95
    v_exp_f32 v8, v8
    v_exp_f32 v9, v9
    v_exp_f32 v10, v10
    v_exp_f32 v11, v11
    v_exp_f32 v12, v12
    v_exp_f32 v13, v13
    v_exp_f32 v14, v14
    v_exp_f32 v15, v15
    v_pk_mul_f32 v[32:33], v[32:33], v[94:95] op_sel_hi:[1,0]
    v_pk_mul_f32 v[34:35], v[34:35], v[94:95] op_sel_hi:[1,0]
    v_pk_mul_f32 v[36:37], v[36:37], v[94:95] op_sel_hi:[1,0]
    v_pk_mul_f32 v[38:39], v[38:39], v[94:95] op_sel_hi:[1,0]
    v_pk_mul_f32 v[40:41], v[40:41], v[94:95] op_sel_hi:[1,0]
    v_pk_mul_f32 v[42:43], v[42:43], v[94:95] op_sel_hi:[1,0]
    v_pk_mul_f32 v[44:45], v[44:45], v[94:95] op_sel_hi:[1,0]
    v_pk_mul_f32 v[46:47], v[46:47], v[94:95] op_sel_hi:[1,0]
    v_pk_mul_f32 v[48:49], v[48:49], v[94:95] op_sel_hi:[1,0]
    v_pk_mul_f32 v[50:51], v[50:51], v[94:95] op_sel_hi:[1,0]
    v_pk_mul_f32 v[52:53], v[52:53], v[94:95] op_sel_hi:[1,0]
    v_pk_mul_f32 v[54:55], v[54:55], v[94:95] op_sel_hi:[1,0]
    v_pk_mul_f32 v[56:57], v[56:57], v[94:95] op_sel_hi:[1,0]
    v_pk_mul_f32 v[58:59], v[58:59], v[94:95] op_sel_hi:[1,0]
    v_pk_mul_f32 v[60:61], v[60:61], v[94:95] op_sel_hi:[1,0]
    v_pk_mul_f32 v[62:63], v[62:63], v[94:95] op_sel_hi:[1,0]
    v_mul_f32 v6, v6, v94
    v_add_f32 v92, v8, v9
    v_add_f32 v93, v10, v11
    v_add_f32 v6, v6, v12
    v_add_f32 v92, v92, v13
    v_add_f32 v93, v93, v14
    v_add_f32 v6, v6, v15
    v_add_f32 v92, v92, v93
    v_cvt_pk_bf16_f32 v8, v8, v9
    v_cvt_pk_bf16_f32 v9, v10, v11
    v_cvt_pk_bf16_f32 v10, v12, v13
    v_cvt_pk_bf16_f32 v11, v14, v15
    v_add_f32 v6, v6, v92
    s_cmp_eq_u32 s28, 0
    s_cbranch_scc1 L_st_novb0
    s_waitcnt vmcnt(8)
    buffer_load_dwordx4 v[240:243], v4, s[44:47], s26 offen offset:0 nt
    buffer_load_dwordx4 v[244:247], v4, s[44:47], s26 offen offset:256 nt
    buffer_load_dwordx4 v[248:251], v4, s[44:47], s26 offen offset:512 nt
    buffer_load_dwordx4 v[252:255], v4, s[44:47], s26 offen offset:768 nt
L_st_novb0:
    s_cmp_lg_u32 s27, 1
    s_cbranch_scc1 L_st_notlast0
    s_waitcnt vmcnt(0)
L_st_notlast0:
    v_perm_b32 v64, v100, v96, s34
    v_perm_b32 v65, v108, v104, s34
    v_perm_b32 v66, v116, v112, s34
    v_perm_b32 v67, v124, v120, s34
    v_perm_b32 v68, v100, v96, s35
    v_perm_b32 v69, v108, v104, s35
    v_perm_b32 v70, v116, v112, s35
    v_perm_b32 v71, v124, v120, s35
    v_mfma_f32_16x16x32_bf16 v[32:35], v[64:67], v[8:11], v[32:35]
    v_perm_b32 v72, v101, v97, s34
    v_perm_b32 v73, v109, v105, s34
    v_perm_b32 v74, v117, v113, s34
    v_perm_b32 v75, v125, v121, s34
    v_mfma_f32_16x16x32_bf16 v[36:39], v[68:71], v[8:11], v[36:39]
    v_perm_b32 v76, v101, v97, s35
    v_perm_b32 v77, v109, v105, s35
    v_perm_b32 v78, v117, v113, s35
    v_perm_b32 v79, v125, v121, s35
    v_mfma_f32_16x16x32_bf16 v[40:43], v[72:75], v[8:11], v[40:43]
    v_perm_b32 v80, v102, v98, s34
    v_perm_b32 v81, v110, v106, s34
    v_perm_b32 v82, v118, v114, s34
    v_perm_b32 v83, v126, v122, s34
    v_mfma_f32_16x16x32_bf16 v[44:47], v[76:79], v[8:11], v[44:47]
    v_perm_b32 v84, v102, v98, s35
    v_perm_b32 v85, v110, v106, s35
    v_perm_b32 v86, v118, v114, s35
    v_perm_b32 v87, v126, v122, s35
    v_mfma_f32_16x16x32_bf16 v[48:51], v[80:83], v[8:11], v[48:51]
    v_perm_b32 v88, v103, v99, s34
    v_perm_b32 v89, v111, v107, s34
    v_perm_b32 v90, v119, v115, s34
    v_perm_b32 v91, v127, v123, s34
    v_mfma_f32_16x16x32_bf16 v[52:55], v[84:87], v[8:11], v[52:55]
    v_perm_b32 v92, v103, v99, s35
    v_perm_b32 v93, v111, v107, s35
    v_perm_b32 v94, v119, v115, s35
    v_perm_b32 v95, v127, v123, s35
    v_mfma_f32_16x16x32_bf16 v[56:59], v[88:91], v[8:11], v[56:59]
    s_nop 0
    v_mfma_f32_16x16x32_bf16 v[60:63], v[92:95], v[8:11], v[60:63]
    s_sub_u32 s27, s27, 1
    s_cmp_eq_u32 s27, 0
    s_cbranch_scc1 L_st_done
    s_mov_b32 s28, 0
    s_cmp_lg_u32 s27, 2
    s_cbranch_scc1 L_st_nok0
    s_cmp_ge_u32 s3, 4
    s_cbranch_scc1 L_st_nok0
    s_waitcnt vmcnt(8)
    s_cmp_lg_u32 s96, 0
    s_cbranch_scc1 L_st_g0
    s_mov_b64 exec, 1
    ds_add_rtn_u32 v7, v3, v4 offset:33024
    s_mov_b64 exec, -1
    s_waitcnt lgkmcnt(0)
    v_readfirstlane_b32 s30, v7
    s_lshl1_add_u32 s24, s30, s6
    s_cmp_ge_u32 s24, s29
    s_cbranch_scc1 L_st_sw0
    s_add_u32 s30, s24, 32768
    s_cmp_ge_u32 s30, s29
    s_cselect_b32 s96, 1, 0
L_st_k0:
    buffer_load_dwordx4 v[64:67], v1, s[40:43], s24 offen offset:0 nt
    buffer_load_dwordx4 v[68:71], v1, s[40:43], s24 offen offset:64 nt
    buffer_load_dwordx4 v[72:75], v1, s[40:43], s24 offen offset:128 nt
    buffer_load_dwordx4 v[76:79], v1, s[40:43], s24 offen offset:192 nt
    s_waitcnt vmcnt(8)
    buffer_load_dwordx4 v[80:83], v2, s[40:43], s24 offen offset:0 nt
    buffer_load_dwordx4 v[84:87], v2, s[40:43], s24 offen offset:64 nt
    buffer_load_dwordx4 v[88:91], v2, s[40:43], s24 offen offset:128 nt
    buffer_load_dwordx4 v[92:95], v2, s[40:43], s24 offen offset:192 nt
    s_mov_b32 s28, 1
    s_mov_b32 s27, 3
L_st_nok0:
    s_cmp_eq_u32 s28, 0
    s_cbranch_scc1 L_st_nova1
    s_waitcnt vmcnt(8)
    s_cmp_eq_u32 s96, 0
    s_cbranch_scc1 L_st_nog1
    v_mov_b32 v7, 1
    s_mov_b64 exec, 1
    buffer_atomic_add v7, off, s[48:51], s97 sc0
    s_mov_b64 exec, -1
L_st_nog1:
    buffer_load_dwordx4 v[96:99], v3, s[44:47], s24 offen offset:0 nt
    buffer_load_dwordx4 v[100:103], v3, s[44:47], s24 offen offset:256 nt
    buffer_load_dwordx4 v[104:107], v3, s[44:47], s24 offen offset:512 nt
    buffer_load_dwordx4 v[108:111], v3, s[44:47], s24 offen offset:768 nt
L_st_go1:
    v_mfma_f32_16x16x32_bf16 v[8:11], v[128:131], v[16:19], 0
    v_mfma_f32_16x16x32_bf16 v[12:15], v[144:147], v[16:19], 0
    v_mfma_f32_16x16x32_bf16 v[8:11], v[132:135], v[20:23], v[8:11]
    v_mfma_f32_16x16x32_bf16 v[12:15], v[148:151], v[20:23], v[12:15]
    v_mfma_f32_16x16x32_bf16 v[8:11], v[136:139], v[24:27], v[8:11]
    v_mfma_f32_16x16x32_bf16 v[12:15], v[152:155], v[24:27], v[12:15]
    v_mfma_f32_16x16x32_bf16 v[8:11], v[140:143], v[28:31], v[8:11]
    v_mfma_f32_16x16x32_bf16 v[12:15], v[156:159], v[28:31], v[12:15]
    s_nop 6
    v_max3_f32 v156, v8, v9, v10
    v_max3_f32 v157, v12, v13, v14
    v_max3_f32 v156, v156, v11, v5
    v_max3_f32 v156, v156, v157, v15
    v_mov_b32 v157, v156
    s_nop 1
    v_permlane32_swap_b32 v156, v157
    v_max_f32 v156, v156, v157
    v_mov_b32 v157, v156
    s_nop 1
    v_permlane16_swap_b32 v156, v157
    v_max_f32 v156, v156, v157
    v_sub_f32 v157, v5, v156
    v_mul_f32 v159, s33, v156
    v_mul_f32 v157, s32, v157
    v_mov_b32 v5, v156
    v_exp_f32 v158, v157
    v_fma_f32 v8, v8, s32, v159
    v_fma_f32 v9, v9, s32, v159
    v_fma_f32 v10, v10, s32, v159
    v_fma_f32 v11, v11, s32, v159
    v_fma_f32 v12, v12, s32, v159
    v_fma_f32 v13, v13, s32, v159
    v_fma_f32 v14, v14, s32, v159
    v_fma_f32 v15, v15, s32, v159
    v_exp_f32 v8, v8
    v_exp_f32 v9, v9
    v_exp_f32 v10, v10
    v_exp_f32 v11, v11
    v_exp_f32 v12, v12
    v_exp_f32 v13, v13
    v_exp_f32 v14, v14
    v_exp_f32 v15, v15
    v_pk_mul_f32 v[32:33], v[32:33], v[158:159] op_sel_hi:[1,0]
    v_pk_mul_f32 v[34:35], v[34:35], v[158:159] op_sel_hi:[1,0]
    v_pk_mul_f32 v[36:37], v[36:37], v[158:159] op_sel_hi:[1,0]
    v_pk_mul_f32 v[38:39], v[38:39], v[158:159] op_sel_hi:[1,0]
    v_pk_mul_f32 v[40:41], v[40:41], v[158:159] op_sel_hi:[1,0]
    v_pk_mul_f32 v[42:43], v[42:43], v[158:159] op_sel_hi:[1,0]
    v_pk_mul_f32 v[44:45], v[44:45], v[158:159] op_sel_hi:[1,0]
    v_pk_mul_f32 v[46:47], v[46:47], v[158:159] op_sel_hi:[1,0]
    v_pk_mul_f32 v[48:49], v[48:49], v[158:159] op_sel_hi:[1,0]
    v_pk_mul_f32 v[50:51], v[50:51], v[158:159] op_sel_hi:[1,0]
    v_pk_mul_f32 v[52:53], v[52:53], v[158:159] op_sel_hi:[1,0]
    v_pk_mul_f32 v[54:55], v[54:55], v[158:159] op_sel_hi:[1,0]
    v_pk_mul_f32 v[56:57], v[56:57], v[158:159] op_sel_hi:[1,0]
    v_pk_mul_f32 v[58:59], v[58:59], v[158:159] op_sel_hi:[1,0]
    v_pk_mul_f32 v[60:61], v[60:61], v[158:159] op_sel_hi:[1,0]
    v_pk_mul_f32 v[62:63], v[62:63], v[158:159] op_sel_hi:[1,0]
    v_mul_f32 v6, v6, v158
    v_add_f32 v156, v8, v9
    v_add_f32 v157, v10, v11
    v_add_f32 v6, v6, v12
    v_add_f32 v156, v156, v13
    v_add_f32 v157, v157, v14
    v_add_f32 v6, v6, v15
    v_add_f32 v156, v156, v157
    v_cvt_pk_bf16_f32 v8, v8, v9
    v_cvt_pk_bf16_f32 v9, v10, v11
    v_cvt_pk_bf16_f32 v10, v12, v13
    v_cvt_pk_bf16_f32 v11, v14, v15
    v_add_f32 v6, v6, v156
    s_cmp_eq_u32 s28, 0
    s_cbranch_scc1 L_st_novb1
    s_waitcnt vmcnt(8)
    buffer_load_dwordx4 v[112:115], v4, s[44:47], s24 offen offset:0 nt
    buffer_load_dwordx4 v[116:119], v4, s[44:47], s24 offen offset:256 nt
    buffer_load_dwordx4 v[120:123], v4, s[44:47], s24 offen offset:512 nt
    buffer_load_dwordx4 v[124:127], v4, s[44:47], s24 offen offset:768 nt
L_st_novb1:
    s_cmp_lg_u32 s27, 1
    s_cbranch_scc1 L_st_notlast1
    s_waitcnt vmcnt(0)
L_st_notlast1:
    v_perm_b32 v128, v164, v160, s34
    v_perm_b32 v129, v172, v168, s34
    v_perm_b32 v130, v180, v176, s34
    v_perm_b32 v131, v188, v184, s34
    v_perm_b32 v132, v164, v160, s35
    v_perm_b32 v133, v172, v168, s35
    v_perm_b32 v134, v180, v176, s35
    v_perm_b32 v135, v188, v184, s35
    v_mfma_f32_16x16x32_bf16 v[32:35], v[128:131], v[8:11], v[32:35]
    v_perm_b32 v136, v165, v161, s34
    v_perm_b32 v137, v173, v169, s34
    v_perm_b32 v138, v181, v177, s34
    v_perm_b32 v139, v189, v185, s34
    v_mfma_f32_16x16x32_bf16 v[36:39], v[132:135], v[8:11], v[36:39]
    v_perm_b32 v140, v165, v161, s35
    v_perm_b32 v141, v173, v169, s35
    v_perm_b32 v142, v181, v177, s35
    v_perm_b32 v143, v189, v185, s35
    v_mfma_f32_16x16x32_bf16 v[40:43], v[136:139], v[8:11], v[40:43]
    v_perm_b32 v144, v166, v162, s34
    v_perm_b32 v145, v174, v170, s34
    v_perm_b32 v146, v182, v178, s34
    v_perm_b32 v147, v190, v186, s34
    v_mfma_f32_16x16x32_bf16 v[44:47], v[140:143], v[8:11], v[44:47]
    v_perm_b32 v148, v166, v162, s35
    v_perm_b32 v149, v174, v170, s35
    v_perm_b32 v150, v182, v178, s35
    v_perm_b32 v151, v190, v186, s35
    v_mfma_f32_16x16x32_bf16 v[48:51], v[144:147], v[8:11], v[48:51]
    v_perm_b32 v152, v167, v163, s34
    v_perm_b32 v153, v175, v171, s34
    v_perm_b32 v154, v183, v179, s34
    v_perm_b32 v155, v191, v187, s34
    v_mfma_f32_16x16x32_bf16 v[52:55], v[148:151], v[8:11], v[52:55]
    v_perm_b32 v156, v167, v163, s35
    v_perm_b32 v157, v175, v171, s35
    v_perm_b32 v158, v183, v179, s35
    v_perm_b32 v159, v191, v187, s35
    v_mfma_f32_16x16x32_bf16 v[56:59], v[152:155], v[8:11], v[56:59]
    s_nop 0
    v_mfma_f32_16x16x32_bf16 v[60:63], v[156:159], v[8:11], v[60:63]
    s_sub_u32 s27, s27, 1
    s_cmp_eq_u32 s27, 0
    s_cbranch_scc1 L_st_done
    s_mov_b32 s28, 0
    s_cmp_lg_u32 s27, 2
    s_cbranch_scc1 L_st_nok1
    s_cmp_ge_u32 s3, 4
    s_cbranch_scc1 L_st_nok1
    s_waitcnt vmcnt(8)
    s_cmp_lg_u32 s96, 0
    s_cbranch_scc1 L_st_g1
    s_mov_b64 exec, 1
    ds_add_rtn_u32 v7, v3, v4 offset:33024
    s_mov_b64 exec, -1
    s_waitcnt lgkmcnt(0)
    v_readfirstlane_b32 s30, v7
    s_lshl1_add_u32 s25, s30, s6
    s_cmp_ge_u32 s25, s29
    s_cbranch_scc1 L_st_sw1
    s_add_u32 s30, s25, 32768
    s_cmp_ge_u32 s30, s29
    s_cselect_b32 s96, 1, 0
L_st_k1:
    buffer_load_dwordx4 v[128:131], v1, s[40:43], s25 offen offset:0 nt
    buffer_load_dwordx4 v[132:135], v1, s[40:43], s25 offen offset:64 nt
    buffer_load_dwordx4 v[136:139], v1, s[40:43], s25 offen offset:128 nt
    buffer_load_dwordx4 v[140:143], v1, s[40:43], s25 offen offset:192 nt
    s_waitcnt vmcnt(8)
    buffer_load_dwordx4 v[144:147], v2, s[40:43], s25 offen offset:0 nt
    buffer_load_dwordx4 v[148:151], v2, s[40:43], s25 offen offset:64 nt
    buffer_load_dwordx4 v[152:155], v2, s[40:43], s25 offen offset:128 nt
    buffer_load_dwordx4 v[156:159], v2, s[40:43], s25 offen offset:192 nt
    s_mov_b32 s28, 1
    s_mov_b32 s27, 3
L_st_nok1:
    s_cmp_eq_u32 s28, 0
    s_cbranch_scc1 L_st_nova2
    s_waitcnt vmcnt(8)
    s_cmp_eq_u32 s96, 0
    s_cbranch_scc1 L_st_nog2
    v_mov_b32 v7, 1
    s_mov_b64 exec, 1
    buffer_atomic_add v7, off, s[48:51], s97 sc0
    s_mov_b64 exec, -1
L_st_nog2:
    buffer_load_dwordx4 v[160:163], v3, s[44:47], s25 offen offset:0 nt
    buffer_load_dwordx4 v[164:167], v3, s[44:47], s25 offen offset:256 nt
    buffer_load_dwordx4 v[168:171], v3, s[44:47], s25 offen offset:512 nt
    buffer_load_dwordx4 v[172:175], v3, s[44:47], s25 offen offset:768 nt
L_st_go2:
    v_mfma_f32_16x16x32_bf16 v[8:11], v[192:195], v[16:19], 0
    v_mfma_f32_16x16x32_bf16 v[12:15], v[208:211], v[16:19], 0
    v_mfma_f32_16x16x32_bf16 v[8:11], v[196:199], v[20:23], v[8:11]
    v_mfma_f32_16x16x32_bf16 v[12:15], v[212:215], v[20:23], v[12:15]
    v_mfma_f32_16x16x32_bf16 v[8:11], v[200:203], v[24:27], v[8:11]
    v_mfma_f32_16x16x32_bf16 v[12:15], v[216:219], v[24:27], v[12:15]
    v_mfma_f32_16x16x32_bf16 v[8:11], v[204:207], v[28:31], v[8:11]
    v_mfma_f32_16x16x32_bf16 v[12:15], v[220:223], v[28:31], v[12:15]
    s_nop 6
    v_max3_f32 v220, v8, v9, v10
    v_max3_f32 v221, v12, v13, v14
    v_max3_f32 v220, v220, v11, v5
    v_max3_f32 v220, v220, v221, v15
    v_mov_b32 v221, v220
    s_nop 1
    v_permlane32_swap_b32 v220, v221
    v_max_f32 v220, v220, v221
    v_mov_b32 v221, v220
    s_nop 1
    v_permlane16_swap_b32 v220, v221
    v_max_f32 v220, v220, v221
    v_sub_f32 v221, v5, v220
    v_mul_f32 v223, s33, v220
    v_mul_f32 v221, s32, v221
    v_mov_b32 v5, v220
    v_exp_f32 v222, v221
    v_fma_f32 v8, v8, s32, v223
    v_fma_f32 v9, v9, s32, v223
    v_fma_f32 v10, v10, s32, v223
    v_fma_f32 v11, v11, s32, v223
    v_fma_f32 v12, v12, s32, v223
    v_fma_f32 v13, v13, s32, v223
    v_fma_f32 v14, v14, s32, v223
    v_fma_f32 v15, v15, s32, v223
    v_exp_f32 v8, v8
    v_exp_f32 v9, v9
    v_exp_f32 v10, v10
    v_exp_f32 v11, v11
    v_exp_f32 v12, v12
    v_exp_f32 v13, v13
    v_exp_f32 v14, v14
    v_exp_f32 v15, v15
    v_pk_mul_f32 v[32:33], v[32:33], v[222:223] op_sel_hi:[1,0]
    v_pk_mul_f32 v[34:35], v[34:35], v[222:223] op_sel_hi:[1,0]
    v_pk_mul_f32 v[36:37], v[36:37], v[222:223] op_sel_hi:[1,0]
    v_pk_mul_f32 v[38:39], v[38:39], v[222:223] op_sel_hi:[1,0]
    v_pk_mul_f32 v[40:41], v[40:41], v[222:223] op_sel_hi:[1,0]
    v_pk_mul_f32 v[42:43], v[42:43], v[222:223] op_sel_hi:[1,0]
    v_pk_mul_f32 v[44:45], v[44:45], v[222:223] op_sel_hi:[1,0]
    v_pk_mul_f32 v[46:47], v[46:47], v[222:223] op_sel_hi:[1,0]
    v_pk_mul_f32 v[48:49], v[48:49], v[222:223] op_sel_hi:[1,0]
    v_pk_mul_f32 v[50:51], v[50:51], v[222:223] op_sel_hi:[1,0]
    v_pk_mul_f32 v[52:53], v[52:53], v[222:223] op_sel_hi:[1,0]
    v_pk_mul_f32 v[54:55], v[54:55], v[222:223] op_sel_hi:[1,0]
    v_pk_mul_f32 v[56:57], v[56:57], v[222:223] op_sel_hi:[1,0]
    v_pk_mul_f32 v[58:59], v[58:59], v[222:223] op_sel_hi:[1,0]
    v_pk_mul_f32 v[60:61], v[60:61], v[222:223] op_sel_hi:[1,0]
    v_pk_mul_f32 v[62:63], v[62:63], v[222:223] op_sel_hi:[1,0]
    v_mul_f32 v6, v6, v222
    v_add_f32 v220, v8, v9
    v_add_f32 v221, v10, v11
    v_add_f32 v6, v6, v12
    v_add_f32 v220, v220, v13
    v_add_f32 v221, v221, v14
    v_add_f32 v6, v6, v15
    v_add_f32 v220, v220, v221
    v_cvt_pk_bf16_f32 v8, v8, v9
    v_cvt_pk_bf16_f32 v9, v10, v11
    v_cvt_pk_bf16_f32 v10, v12, v13
    v_cvt_pk_bf16_f32 v11, v14, v15
    v_add_f32 v6, v6, v220
    s_cmp_eq_u32 s28, 0
    s_cbranch_scc1 L_st_novb2
    s_waitcnt vmcnt(8)
    buffer_load_dwordx4 v[176:179], v4, s[44:47], s25 offen offset:0 nt
    buffer_load_dwordx4 v[180:183], v4, s[44:47], s25 offen offset:256 nt
    buffer_load_dwordx4 v[184:187], v4, s[44:47], s25 offen offset:512 nt
    buffer_load_dwordx4 v[188:191], v4, s[44:47], s25 offen offset:768 nt
L_st_novb2:
    s_cmp_lg_u32 s27, 1
    s_cbranch_scc1 L_st_notlast2
    s_waitcnt vmcnt(0)
L_st_notlast2:
    v_perm_b32 v192, v228, v224, s34
    v_perm_b32 v193, v236, v232, s34
    v_perm_b32 v194, v244, v240, s34
    v_perm_b32 v195, v252, v248, s34
    v_perm_b32 v196, v228, v224, s35
    v_perm_b32 v197, v236, v232, s35
    v_perm_b32 v198, v244, v240, s35
    v_perm_b32 v199, v252, v248, s35
    v_mfma_f32_16x16x32_bf16 v[32:35], v[192:195], v[8:11], v[32:35]
    v_perm_b32 v200, v229, v225, s34
    v_perm_b32 v201, v237, v233, s34
    v_perm_b32 v202, v245, v241, s34
    v_perm_b32 v203, v253, v249, s34
    v_mfma_f32_16x16x32_bf16 v[36:39], v[196:199], v[8:11], v[36:39]
    v_perm_b32 v204, v229, v225, s35
    v_perm_b32 v205, v237, v233, s35
    v_perm_b32 v206, v245, v241, s35
    v_perm_b32 v207, v253, v249, s35
    v_mfma_f32_16x16x32_bf16 v[40:43], v[200:203], v[8:11], v[40:43]
    v_perm_b32 v208, v230, v226, s34
    v_perm_b32 v209, v238, v234, s34
    v_perm_b32 v210, v246, v242, s34
    v_perm_b32 v211, v254, v250, s34
    v_mfma_f32_16x16x32_bf16 v[44:47], v[204:207], v[8:11], v[44:47]
    v_perm_b32 v212, v230, v226, s35
    v_perm_b32 v213, v238, v234, s35
    v_perm_b32 v214, v246, v242, s35
    v_perm_b32 v215, v254, v250, s35
    v_mfma_f32_16x16x32_bf16 v[48:51], v[208:211], v[8:11], v[48:51]
    v_perm_b32 v216, v231, v227, s34
    v_perm_b32 v217, v239, v235, s34
    v_perm_b32 v218, v247, v243, s34
    v_perm_b32 v219, v255, v251, s34
    v_mfma_f32_16x16x32_bf16 v[52:55], v[212:215], v[8:11], v[52:55]
    v_perm_b32 v220, v231, v227, s35
    v_perm_b32 v221, v239, v235, s35
    v_perm_b32 v222, v247, v243, s35
    v_perm_b32 v223, v255, v251, s35
    v_mfma_f32_16x16x32_bf16 v[56:59], v[216:219], v[8:11], v[56:59]
    s_nop 0
    v_mfma_f32_16x16x32_bf16 v[60:63], v[220:223], v[8:11], v[60:63]
    s_sub_u32 s27, s27, 1
    s_cmp_eq_u32 s27, 0
    s_cbranch_scc1 L_st_done
    s_mov_b32 s28, 0
    s_cmp_lg_u32 s27, 2
    s_cbranch_scc1 L_st_nok2
    s_cmp_ge_u32 s3, 4
    s_cbranch_scc1 L_st_nok2
    s_waitcnt vmcnt(8)
    s_cmp_lg_u32 s96, 0
    s_cbranch_scc1 L_st_g2
    s_mov_b64 exec, 1
    ds_add_rtn_u32 v7, v3, v4 offset:33024
    s_mov_b64 exec, -1
    s_waitcnt lgkmcnt(0)
    v_readfirstlane_b32 s30, v7
    s_lshl1_add_u32 s26, s30, s6
    s_cmp_ge_u32 s26, s29
    s_cbranch_scc1 L_st_sw2
    s_add_u32 s30, s26, 32768
    s_cmp_ge_u32 s30, s29
    s_cselect_b32 s96, 1, 0
L_st_k2:
    buffer_load_dwordx4 v[192:195], v1, s[40:43], s26 offen offset:0 nt
    buffer_load_dwordx4 v[196:199], v1, s[40:43], s26 offen offset:64 nt
    buffer_load_dwordx4 v[200:203], v1, s[40:43], s26 offen offset:128 nt
    buffer_load_dwordx4 v[204:207], v1, s[40:43], s26 offen offset:192 nt
    s_waitcnt vmcnt(8)
    buffer_load_dwordx4 v[208:211], v2, s[40:43], s26 offen offset:0 nt
    buffer_load_dwordx4 v[212:215], v2, s[40:43], s26 offen offset:64 nt
    buffer_load_dwordx4 v[216:219], v2, s[40:43], s26 offen offset:128 nt
    buffer_load_dwordx4 v[220:223], v2, s[40:43], s26 offen offset:192 nt
    s_mov_b32 s28, 1
    s_mov_b32 s27, 3
L_st_nok2:
    s_branch L_st_loop
L_st_nova0:
    s_waitcnt vmcnt(32)
    s_cmp_eq_u32 s27, 3
    s_cbranch_scc1 L_st_go0
    s_waitcnt vmcnt(16)
    s_cmp_eq_u32 s27, 2
    s_cbranch_scc1 L_st_go0
    s_waitcnt vmcnt(8)
    s_branch L_st_go0
L_st_sw0:
    s_mov_b32 s96, 1
    v_mov_b32 v7, 1
    s_mov_b64 exec, 1
    buffer_atomic_add v7, off, s[48:51], s97 sc0
    s_mov_b64 exec, -1
    s_waitcnt vmcnt(0)
L_st_g0:
    v_readfirstlane_b32 s30, v7
    s_cmp_ge_u32 s30, 64
    s_cbranch_scc1 L_st_nok0
    s_lshr_b32 s4, s30, 4
    s_add_u32 s4, s4, 58
    s_bitcmp1_b32 s30, 0
    s_cselect_b32 s5, 66, 0
    s_add_u32 s4, s4, s5
    s_bfe_u32 s5, s30, 0x30001
    s_lshl_b32 s5, s5, 7
    s_add_u32 s4, s4, s5
    s_lshl_b32 s24, s4, 13
    s_branch L_st_k0
L_st_nova1:
    s_waitcnt vmcnt(32)
    s_cmp_eq_u32 s27, 3
    s_cbranch_scc1 L_st_go1
    s_waitcnt vmcnt(16)
    s_cmp_eq_u32 s27, 2
    s_cbranch_scc1 L_st_go1
    s_waitcnt vmcnt(8)
    s_branch L_st_go1
L_st_sw1:
    s_mov_b32 s96, 1
    v_mov_b32 v7, 1
    s_mov_b64 exec, 1
    buffer_atomic_add v7, off, s[48:51], s97 sc0
    s_mov_b64 exec, -1
    s_waitcnt vmcnt(0)
L_st_g1:
    v_readfirstlane_b32 s30, v7
    s_cmp_ge_u32 s30, 64
    s_cbranch_scc1 L_st_nok1
    s_lshr_b32 s4, s30, 4
    s_add_u32 s4, s4, 58
    s_bitcmp1_b32 s30, 0
    s_cselect_b32 s5, 66, 0
    s_add_u32 s4, s4, s5
    s_bfe_u32 s5, s30, 0x30001
    s_lshl_b32 s5, s5, 7
    s_add_u32 s4, s4, s5
    s_lshl_b32 s25, s4, 13
    s_branch L_st_k1
L_st_nova2:
    s_waitcnt vmcnt(32)
    s_cmp_eq_u32 s27, 3
    s_cbranch_scc1 L_st_go2
    s_waitcnt vmcnt(16)
    s_cmp_eq_u32 s27, 2
    s_cbranch_scc1 L_st_go2
    s_waitcnt vmcnt(8)
    s_branch L_st_go2
L_st_sw2:
    s_mov_b32 s96, 1
    v_mov_b32 v7, 1
    s_mov_b64 exec, 1
    buffer_atomic_add v7, off, s[48:51], s97 sc0
    s_mov_b64 exec, -1
    s_waitcnt vmcnt(0)
L_st_g2:
    v_readfirstlane_b32 s30, v7
    s_cmp_ge_u32 s30, 64
    s_cbranch_scc1 L_st_nok2
    s_lshr_b32 s4, s30, 4
    s_add_u32 s4, s4, 58
    s_bitcmp1_b32 s30, 0
    s_cselect_b32 s5, 66, 0
    s_add_u32 s4, s4, s5
    s_bfe_u32 s5, s30, 0x30001
    s_lshl_b32 s5, s5, 7
    s_add_u32 s4, s4, s5
    s_lshl_b32 s26, s4, 13
    s_branch L_st_k2
L_st_nowork:
    v_mov_b32 v32, 0
    v_mov_b32 v33, 0
    v_mov_b32 v34, 0
    v_mov_b32 v35, 0
    v_mov_b32 v36, 0
    v_mov_b32 v37, 0
    v_mov_b32 v38, 0
    v_mov_b32 v39, 0
    v_mov_b32 v40, 0
    v_mov_b32 v41, 0
    v_mov_b32 v42, 0
    v_mov_b32 v43, 0
    v_mov_b32 v44, 0
    v_mov_b32 v45, 0
    v_mov_b32 v46, 0
    v_mov_b32 v47, 0
    v_mov_b32 v48, 0
    v_mov_b32 v49, 0
    v_mov_b32 v50, 0
    v_mov_b32 v51, 0
    v_mov_b32 v52, 0
    v_mov_b32 v53, 0
    v_mov_b32 v54, 0
    v_mov_b32 v55, 0
    v_mov_b32 v56, 0
    v_mov_b32 v57, 0
    v_mov_b32 v58, 0
    v_mov_b32 v59, 0
    v_mov_b32 v60, 0
    v_mov_b32 v61, 0
    v_mov_b32 v62, 0
    v_mov_b32 v63, 0
L_st_done:
    v_mov_b32 v7, v6
    s_nop 1
    v_permlane32_swap_b32 v6, v7
    v_add_f32 v6, v6, v7
    v_mov_b32 v7, v6
    s_nop 1
    v_permlane16_swap_b32 v6, v7
    v_add_f32 v6, v6, v7
    v_mul_f32 v5, s32, v5
    v_and_b32 v1, 15, v0
    v_lshrrev_b32 v2, 4, v0
    v_lshl_add_u32 v2, v1, 2, v2
    v_lshlrev_b32 v2, 4, v2
    s_lshl_b32 s4, s3, 11
    v_add_u32 v2, s4, v2
    s_lshl_b32 s4, s3, 2
    v_lshl_add_u32 v1, v1, 5, s4
    s_mov_b32 exec_lo, 0x000f000f
    s_mov_b32 exec_hi, 0x000f000f
    ds_write_b128 v2, v[32:35] offset:0
    ds_write_b128 v2, v[36:39] offset:256
    ds_write_b128 v2, v[40:43] offset:512
    ds_write_b128 v2, v[44:47] offset:768
    ds_write_b128 v2, v[48:51] offset:1024
    ds_write_b128 v2, v[52:55] offset:1280
    ds_write_b128 v2, v[56:59] offset:1536
    ds_write_b128 v2, v[60:63] offset:1792
    s_mov_b64 exec, 15
    ds_write_b32 v1, v5 offset:32768
    ds_write_b32 v1, v6 offset:32896
    s_mov_b64 exec, -1
    s_cmp_ge_u32 s3, 4
    s_cbranch_scc1 L_tail
    s_waitcnt lgkmcnt(0)
    s_barrier
    s_endpgm
L_w0:
    s_mov_b32 s64, s80
    s_mov_b32 s65, s81
    s_mov_b32 s66, 4194304
    s_mov_b32 s67, 0x00020000
    s_load_dword s39, s[48:49], 4
    s_setprio 3
    s_and_b32 s4, s2, 7
    s_lshl_b32 s4, s4, 3
    s_lshr_b32 s5, s2, 5
    s_add_u32 s4, s4, s5
    s_lshl_b32 s4, s4, 16
    s_bfe_u32 s5, s2, 0x20003
    s_lshl_b32 s5, s5, 8
    s_add_u32 s4, s4, s5
    v_lshrrev_b32 v64, 4, v0
    v_lshlrev_b32 v64, 13, v64
    v_and_b32 v65, 15, v0
    v_lshl_add_u32 v64, v65, 4, v64
    v_lshlrev_b32 v122, 4, v0
    s_mov_b32 s31, 0
    s_barrier
    buffer_load_dwordx4 v[128:131], v64, s[64:67], s4 offen offset:0 nt
    buffer_load_dwordx4 v[132:135], v64, s[64:67], s4 offen offset:1024 nt
    buffer_load_dwordx4 v[136:139], v64, s[64:67], s4 offen offset:2048 nt
    buffer_load_dwordx4 v[140:143], v64, s[64:67], s4 offen offset:3072 nt
    s_add_u32 s5, s4, 4096
    buffer_load_dwordx4 v[144:147], v64, s[64:67], s5 offen offset:0 nt
    buffer_load_dwordx4 v[148:151], v64, s[64:67], s5 offen offset:1024 nt
    buffer_load_dwordx4 v[152:155], v64, s[64:67], s5 offen offset:2048 nt
    buffer_load_dwordx4 v[156:159], v64, s[64:67], s5 offen offset:3072 nt
    s_add_u32 s5, s4, 32768
    buffer_load_dwordx4 v[160:163], v64, s[64:67], s5 offen offset:0 nt
    buffer_load_dwordx4 v[164:167], v64, s[64:67], s5 offen offset:1024 nt
    buffer_load_dwordx4 v[168:171], v64, s[64:67], s5 offen offset:2048 nt
    buffer_load_dwordx4 v[172:175], v64, s[64:67], s5 offen offset:3072 nt
    s_add_u32 s5, s4, 36864
    buffer_load_dwordx4 v[176:179], v64, s[64:67], s5 offen offset:0 nt
    buffer_load_dwordx4 v[180:183], v64, s[64:67], s5 offen offset:1024 nt
    buffer_load_dwordx4 v[184:187], v64, s[64:67], s5 offen offset:2048 nt
    buffer_load_dwordx4 v[188:191], v64, s[64:67], s5 offen offset:3072 nt
    s_bfe_u32 s93, s2, 0x30003
    s_lshl_b32 s93, s93, 12
    s_bfe_u32 s5, s2, 0x10006
    s_lshl_b32 s5, s5, 11
    s_add_u32 s93, s93, s5
    s_add_u32 s93, s93, 4096
    v_lshlrev_b32 v72, 3, v0
    v_mov_b32 v73, 1
    s_waitcnt lgkmcnt(0)
    s_mul_i32 s36, s39, 0x9E3779B1
    s_add_u32 s36, s36, 0x7F4A7C15
    s_waitcnt vmcnt(8)
    v_perm_b32 v192, v132, v128, s34
    v_perm_b32 v193, v140, v136, s34
    v_perm_b32 v194, v148, v144, s34
    v_perm_b32 v195, v156, v152, s34
    v_perm_b32 v196, v132, v128, s35
    v_perm_b32 v197, v140, v136, s35
    v_perm_b32 v198, v148, v144, s35
    v_perm_b32 v199, v156, v152, s35
    v_perm_b32 v200, v133, v129, s34
    v_perm_b32 v201, v141, v137, s34
    v_perm_b32 v202, v149, v145, s34
    v_perm_b32 v203, v157, v153, s34
    v_perm_b32 v204, v133, v129, s35
    v_perm_b32 v205, v141, v137, s35
    v_perm_b32 v206, v149, v145, s35
    v_perm_b32 v207, v157, v153, s35
    v_perm_b32 v208, v134, v130, s34
    v_perm_b32 v209, v142, v138, s34
    v_perm_b32 v210, v150, v146, s34
    v_perm_b32 v211, v158, v154, s34
    v_perm_b32 v212, v134, v130, s35
    v_perm_b32 v213, v142, v138, s35
    v_perm_b32 v214, v150, v146, s35
    v_perm_b32 v215, v158, v154, s35
    v_perm_b32 v216, v135, v131, s34
    v_perm_b32 v217, v143, v139, s34
    v_perm_b32 v218, v151, v147, s34
    v_perm_b32 v219, v159, v155, s34
    v_perm_b32 v220, v135, v131, s35
    v_perm_b32 v221, v143, v139, s35
    v_perm_b32 v222, v151, v147, s35
    v_perm_b32 v223, v159, v155, s35
    ds_write_b128 v122, v[192:195] offset:16384
    ds_write_b128 v122, v[196:199] offset:17408
    ds_write_b128 v122, v[200:203] offset:18432
    ds_write_b128 v122, v[204:207] offset:19456
    ds_write_b128 v122, v[208:211] offset:20480
    ds_write_b128 v122, v[212:215] offset:21504
    ds_write_b128 v122, v[216:219] offset:22528
    ds_write_b128 v122, v[220:223] offset:23552
    s_waitcnt vmcnt(0)
    v_perm_b32 v224, v164, v160, s34
    v_perm_b32 v225, v172, v168, s34
    v_perm_b32 v226, v180, v176, s34
    v_perm_b32 v227, v188, v184, s34
    v_perm_b32 v228, v164, v160, s35
    v_perm_b32 v229, v172, v168, s35
    v_perm_b32 v230, v180, v176, s35
    v_perm_b32 v231, v188, v184, s35
    v_perm_b32 v232, v165, v161, s34
    v_perm_b32 v233, v173, v169, s34
    v_perm_b32 v234, v181, v177, s34
    v_perm_b32 v235, v189, v185, s34
    v_perm_b32 v236, v165, v161, s35
    v_perm_b32 v237, v173, v169, s35
    v_perm_b32 v238, v181, v177, s35
    v_perm_b32 v239, v189, v185, s35
    v_perm_b32 v240, v166, v162, s34
    v_perm_b32 v241, v174, v170, s34
    v_perm_b32 v242, v182, v178, s34
    v_perm_b32 v243, v190, v186, s34
    v_perm_b32 v244, v166, v162, s35
    v_perm_b32 v245, v174, v170, s35
    v_perm_b32 v246, v182, v178, s35
    v_perm_b32 v247, v190, v186, s35
    v_perm_b32 v248, v167, v163, s34
    v_perm_b32 v249, v175, v171, s34
    v_perm_b32 v250, v183, v179, s34
    v_perm_b32 v251, v191, v187, s34
    v_perm_b32 v252, v167, v163, s35
    v_perm_b32 v253, v175, v171, s35
    v_perm_b32 v254, v183, v179, s35
    v_perm_b32 v255, v191, v187, s35
    ds_write_b128 v122, v[224:227] offset:24576
    ds_write_b128 v122, v[228:231] offset:25600
    ds_write_b128 v122, v[232:235] offset:26624
    ds_write_b128 v122, v[236:239] offset:27648
    ds_write_b128 v122, v[240:243] offset:28672
    ds_write_b128 v122, v[244:247] offset:29696
    ds_write_b128 v122, v[248:251] offset:30720
    ds_write_b128 v122, v[252:255] offset:31744
    s_mov_b64 s[78:79], -1
    s_mov_b64 s[80:81], -1
    s_mov_b32 s92, 65536
L_qpoll_top:
    s_mov_b64 exec, s[78:79]
    s_cbranch_execz L_qpoll_s0
    buffer_load_dwordx4 v[64:67], v122, s[48:51], s93 offen sc1
L_qpoll_s0:
    s_mov_b64 exec, s[80:81]
    s_cbranch_execz L_qpoll_s1
    buffer_load_dwordx4 v[68:71], v122, s[48:51], s93 offen offset:1024 sc1
L_qpoll_s1:
    s_waitcnt vmcnt(0)
    s_mov_b64 exec, s[78:79]
    v_cmp_ne_u32_e64 s[78:79], v65, s36
    v_cmp_ne_u32_e64 vcc, v67, s36
    s_or_b64 s[78:79], s[78:79], vcc
    s_mov_b64 exec, s[80:81]
    v_cmp_ne_u32_e64 s[80:81], v69, s36
    v_cmp_ne_u32_e64 vcc, v71, s36
    s_or_b64 s[80:81], s[80:81], vcc
    s_mov_b64 exec, -1
    s_mov_b64 s[4:5], s[78:79]
    s_or_b64 s[4:5], s[4:5], s[80:81]
    s_cmp_eq_u64 s[4:5], 0
    s_cbranch_scc1 L_qpoll_done
    s_sleep 2
    s_sub_u32 s92, s92, 1
    s_cmp_lg_u32 s92, 0
    s_cbranch_scc1 L_qpoll_top
L_qpoll_done:
    v_add_u32 v72, 33280, v72
    ds_write2_b32 v72, v64, v66 offset0:0 offset1:1
    ds_write2_b32 v72, v68, v70 offset0:128 offset1:129
    v_mov_b32 v72, 0
    s_waitcnt lgkmcnt(0)
    ds_write_b32 v72, v73 offset:33032
    s_branch L_stream
L_helper:
    s_sub_u32 s37, s3, 4
    s_mov_b32 s31, 0
    s_cmp_lt_u32 s2, 92
    s_cbranch_scc1 L_hb_skip
    s_barrier
L_hb_skip:
    s_mov_b32 s52, s72
    s_mov_b32 s53, s73
    s_mov_b32 s54, 2048
    s_mov_b32 s55, 0x00020000
    s_setprio 3
    v_lshrrev_b32 v1, 3, v0
    v_and_b32 v14, 7, v0
    s_cmp_lt_u32 s2, 64
    s_cbranch_scc1 L_role_q
    s_cmp_lt_u32 s2, 92
    s_cbranch_scc1 L_role_h
    s_cmp_lt_u32 s2, 96
    s_cbranch_scc1 L_role_none
    s_cmp_lt_u32 s2, 128
    s_cbranch_scc1 L_role_g
    s_cmp_ge_u32 s2, 160
    s_cbranch_scc1 L_role_none
    s_cmp_eq_u32 s3, 7
    s_cbranch_scc1 L_role_f
L_role_none:
    s_waitcnt lgkmcnt(0)
L_join:
    s_mov_b64 exec, -1
    s_bfe_u32 s6, s2, 0x30003
    s_bfe_u32 s7, s2, 0x10006
    s_and_b32 s5, s2, 7
    s_lshl_b32 s5, s5, 1
    s_lshr_b32 s4, s2, 7
    s_add_u32 s5, s5, s4
    s_lshl_b32 s4, s6, 1
    s_add_u32 s4, s4, s7
    s_lshl_b32 s4, s4, 4
    s_add_u32 s4, s4, s5
    s_lshl_b32 s4, s4, 2
    s_add_u32 s4, s4, s37
    s_lshl_b32 s4, s4, 10
    s_add_u32 s72, s4, 131072
    s_lshl_b32 s4, s6, 2
    s_add_u32 s4, s4, s37
    s_lshl_b32 s4, s4, 1
    s_add_u32 s4, s4, s7
    s_lshl_b32 s4, s4, 4
    s_add_u32 s4, s4, s5
    s_lshl_b32 s4, s4, 4
    s_add_u32 s73, s4, 1179648
    s_and_b32 s93, s2, 7
    s_lshr_b32 s5, s37, 1
    s_and_b32 s38, s37, 1
    s_lshl_b32 s38, s38, 3
    s_lshr_b32 s94, s2, 5
    s_lshl_b32 s4, s93, 1
    s_add_u32 s4, s4, s5
    s_lshl_b32 s4, s4, 4
    s_add_u32 s4, s4, s38
    s_lshl_b32 s4, s4, 3
    s_add_u32 s4, s4, s94
    s_lshl_b32 s4, s4, 9
    s_add_u32 s98, s4, 131072
    s_add_u32 s99, s98, 0x2000
    s_add_u32 s100, s98, 0x4000
    s_add_u32 s101, s98, 0x6000
    s_lshl_b32 s4, s93, 3
    s_add_u32 s4, s4, s94
    s_and_b32 s6, s4, 0xfffffffe
    s_add_u32 s6, s6, s5
    s_lshl_b32 s6, s6, 8
    s_add_u32 s74, s6, 1179648
    s_lshl_b32 s4, s4, 8
    s_bfe_u32 s5, s2, 0x20003
    s_lshl_b32 s5, s5, 17
    s_add_u32 s4, s4, s5
    s_add_u32 s75, s4, 1245184
    s_add_u32 s76, s75, 0x4000
    s_and_b32 s4, s2, 31
    s_lshl_b32 s95, s4, 5
    s_lshl_b32 s4, s4, 14
    s_lshl_b32 s5, s37, 12
    s_add_u32 s4, s4, s5
    s_add_u32 s77, s4, 1245184
    s_branch L_stream
L_role_q:
    s_mov_b32 s56, s78
    s_mov_b32 s57, s79
    s_mov_b32 s58, 4194304
    s_mov_b32 s59, 0x00020000
    s_mov_b32 s96, s2
    s_and_b32 s5, s2, 7
    s_or_b32 s5, s5, s37
    s_cmp_lg_u32 s5, 0
    s_cbranch_scc1 L_cinit_skip
    s_lshr_b32 s5, s2, 3
    s_mul_i32 s5, s5, 4096
    s_add_u32 s5, s5, 1835008
    v_mul_u32_u24 v98, 32768, v0
    v_mov_b32 v99, 0
    s_mov_b64 exec, 3
    buffer_store_dword v99, v98, s[48:51], s5 offen sc1
    s_mov_b64 exec, -1
L_cinit_skip:
    v_lshlrev_b32 v98, 17, v1
    s_lshl_b32 s4, s37, 20
    v_lshl_add_u32 v98, v14, 4, v98
    s_lshl_b32 s5, s96, 7
    s_add_u32 s4, s4, s5
    v_lshlrev_b32 v15, 5, v0
    buffer_load_dwordx4 v[2:5], v15, s[52:55], 0 offen
    buffer_load_dwordx4 v[6:9], v15, s[52:55], 0 offen offset:16
    buffer_load_dwordx4 v[128:131], v98, s[56:59], s4 offen nt
    s_add_u32 s4, s4, 8192
    buffer_load_dwordx4 v[132:135], v98, s[56:59], s4 offen nt
    s_add_u32 s4, s4, 8192
    buffer_load_dwordx4 v[136:139], v98, s[56:59], s4 offen nt
    s_add_u32 s4, s4, 8192
    buffer_load_dwordx4 v[140:143], v98, s[56:59], s4 offen nt
    s_add_u32 s4, s4, 8192
    buffer_load_dwordx4 v[144:147], v98, s[56:59], s4 offen nt
    s_add_u32 s4, s4, 8192
    buffer_load_dwordx4 v[148:151], v98, s[56:59], s4 offen nt
    s_add_u32 s4, s4, 8192
    buffer_load_dwordx4 v[152:155], v98, s[56:59], s4 offen nt
    s_add_u32 s4, s4, 8192
    buffer_load_dwordx4 v[156:159], v98, s[56:59], s4 offen nt
    s_add_u32 s4, s4, 8192
    buffer_load_dwordx4 v[160:163], v98, s[56:59], s4 offen nt
    s_add_u32 s4, s4, 8192
    buffer_load_dwordx4 v[164:167], v98, s[56:59], s4 offen nt
    s_add_u32 s4, s4, 8192
    buffer_load_dwordx4 v[168:171], v98, s[56:59], s4 offen nt
    s_add_u32 s4, s4, 8192
    buffer_load_dwordx4 v[172:175], v98, s[56:59], s4 offen nt
    s_add_u32 s4, s4, 8192
    buffer_load_dwordx4 v[176:179], v98, s[56:59], s4 offen nt
    s_add_u32 s4, s4, 8192
    buffer_load_dwordx4 v[180:183], v98, s[56:59], s4 offen nt
    s_add_u32 s4, s4, 8192
    buffer_load_dwordx4 v[184:187], v98, s[56:59], s4 offen nt
    s_add_u32 s4, s4, 8192
    buffer_load_dwordx4 v[188:191], v98, s[56:59], s4 offen nt
    s_waitcnt lgkmcnt(0)
    s_load_dword s39, s[48:49], 4
    s_barrier
    v_lshrrev_b32 v120, 5, v0
    v_lshlrev_b32 v120, 8, v120
    v_bfe_u32 v123, v0, 4, 1
    v_lshl_add_u32 v120, v123, 4, v120
    v_and_b32 v123, 7, v0
    v_lshl_add_u32 v120, v123, 5, v120
    s_lshl_b32 s5, s37, 9
    v_add_u32 v120, s5, v120
    v_lshlrev_b32 v122, 4, v0
    v_mov_b32 v121, 1
    v_mov_b32 v101, 0
    s_lshl_b32 s4, s37, 5
    v_lshl_add_u32 v97, v1, 2, s4
    v_lshrrev_b32 v125, 4, v0
    v_and_b32 v126, 15, v0
    v_lshlrev_b32 v126, 4, v126
    s_waitcnt vmcnt(16)
    v_lshlrev_b32 v32, 16, v2
    v_and_b32 v33, 0xffff0000, v2
    v_lshlrev_b32 v34, 16, v3
    v_and_b32 v35, 0xffff0000, v3
    v_lshlrev_b32 v36, 16, v4
    v_and_b32 v37, 0xffff0000, v4
    v_lshlrev_b32 v38, 16, v5
    v_and_b32 v39, 0xffff0000, v5
    v_lshlrev_b32 v40, 16, v6
    v_and_b32 v41, 0xffff0000, v6
    v_lshlrev_b32 v42, 16, v7
    v_and_b32 v43, 0xffff0000, v7
    v_lshlrev_b32 v44, 16, v8
    v_and_b32 v45, 0xffff0000, v8
    v_lshlrev_b32 v46, 16, v9
    v_and_b32 v47, 0xffff0000, v9
    v_pk_add_f32 v[64:65], v[32:33], v[34:35]
    v_pk_add_f32 v[66:67], v[36:37], v[38:39]
    v_pk_add_f32 v[68:69], v[40:41], v[42:43]
    v_pk_add_f32 v[70:71], v[44:45], v[46:47]
    v_pk_add_f32 v[64:65], v[64:65], v[66:67]
    v_pk_add_f32 v[68:69], v[68:69], v[70:71]
    v_pk_add_f32 v[64:65], v[64:65], v[68:69]
    v_add_f32 v60, v64, v65
    s_nop 1
    v_add_f32_dpp v60, v60, v60 row_ror:8 row_mask:0xf bank_mask:0xf
    s_nop 1
    v_add_f32_dpp v60, v60, v60 row_ror:4 row_mask:0xf bank_mask:0xf
    s_nop 1
    v_add_f32_dpp v60, v60, v60 row_ror:2 row_mask:0xf bank_mask:0xf
    s_nop 1
    v_add_f32_dpp v60, v60, v60 row_ror:1 row_mask:0xf bank_mask:0xf
    v_mov_b32 v64, v60
    s_nop 1
    v_permlane16_swap_b32 v60, v64
    v_add_f32 v60, v60, v64
    v_mul_f32 v60, 0x3b000000, v60
    v_mov_b32 v65, v60
    v_mov_b32 v64, v60
    v_pk_add_f32 v[72:73], v[32:33], v[64:65] neg_lo:[0,1] neg_hi:[0,1]
    v_pk_add_f32 v[74:75], v[34:35], v[64:65] neg_lo:[0,1] neg_hi:[0,1]
    v_pk_add_f32 v[76:77], v[36:37], v[64:65] neg_lo:[0,1] neg_hi:[0,1]
    v_pk_add_f32 v[78:79], v[38:39], v[64:65] neg_lo:[0,1] neg_hi:[0,1]
    v_pk_add_f32 v[80:81], v[40:41], v[64:65] neg_lo:[0,1] neg_hi:[0,1]
    v_pk_add_f32 v[82:83], v[42:43], v[64:65] neg_lo:[0,1] neg_hi:[0,1]
    v_pk_add_f32 v[84:85], v[44:45], v[64:65] neg_lo:[0,1] neg_hi:[0,1]
    v_pk_add_f32 v[86:87], v[46:47], v[64:65] neg_lo:[0,1] neg_hi:[0,1]
    v_pk_mul_f32 v[72:73], v[72:73], v[72:73]
    v_pk_mul_f32 v[74:75], v[74:75], v[74:75]
    v_pk_mul_f32 v[76:77], v[76:77], v[76:77]
    v_pk_mul_f32 v[78:79], v[78:79], v[78:79]
    v_pk_mul_f32 v[80:81], v[80:81], v[80:81]
    v_pk_mul_f32 v[82:83], v[82:83], v[82:83]
    v_pk_mul_f32 v[84:85], v[84:85], v[84:85]
    v_pk_mul_f32 v[86:87], v[86:87], v[86:87]
    v_pk_add_f32 v[64:65], v[72:73], v[74:75]
    v_pk_add_f32 v[66:67], v[76:77], v[78:79]
    v_pk_add_f32 v[68:69], v[80:81], v[82:83]
    v_pk_add_f32 v[70:71], v[84:85], v[86:87]
    v_pk_add_f32 v[64:65], v[64:65], v[66:67]
    v_pk_add_f32 v[68:69], v[68:69], v[70:71]
    v_pk_add_f32 v[64:65], v[64:65], v[68:69]
    v_add_f32 v61, v64, v65
    s_nop 1
    v_add_f32_dpp v61, v61, v61 row_ror:8 row_mask:0xf bank_mask:0xf
    s_nop 1
    v_add_f32_dpp v61, v61, v61 row_ror:4 row_mask:0xf bank_mask:0xf
    s_nop 1
    v_add_f32_dpp v61, v61, v61 row_ror:2 row_mask:0xf bank_mask:0xf
    s_nop 1
    v_add_f32_dpp v61, v61, v61 row_ror:1 row_mask:0xf bank_mask:0xf
    v_mov_b32 v64, v61
    s_nop 1
    v_permlane16_swap_b32 v61, v64
    v_add_f32 v61, v61, v64
    v_mul_f32 v61, 0x3b000000, v61
    v_cvt_pk_bf16_f32 v60, v60, v60
    v_and_b32 v60, 0xffff0000, v60
    v_cvt_pk_bf16_f32 v61, v61, v61
    v_and_b32 v61, 0xffff0000, v61
    v_add_f32 v61, 0x3727c5ac, v61
    v_cvt_pk_bf16_f32 v61, v61, v61
    v_and_b32 v61, 0xffff0000, v61
    v_sqrt_f32 v61, v61
    s_nop 0
    v_cvt_pk_bf16_f32 v61, v61, v61
    v_and_b32 v61, 0xffff0000, v61
    v_rcp_f32 v61, v61
    v_sub_f32 v32, v32, v60
    v_sub_f32 v33, v33, v60
    v_sub_f32 v34, v34, v60
    v_sub_f32 v35, v35, v60
    v_sub_f32 v36, v36, v60
    v_sub_f32 v37, v37, v60
    v_sub_f32 v38, v38, v60
    v_sub_f32 v39, v39, v60
    v_sub_f32 v40, v40, v60
    v_sub_f32 v41, v41, v60
    v_sub_f32 v42, v42, v60
    v_sub_f32 v43, v43, v60
    v_sub_f32 v44, v44, v60
    v_sub_f32 v45, v45, v60
    v_sub_f32 v46, v46, v60
    v_sub_f32 v47, v47, v60
    v_cvt_pk_bf16_f32 v48, v32, v33
    v_cvt_pk_bf16_f32 v49, v34, v35
    v_cvt_pk_bf16_f32 v50, v36, v37
    v_cvt_pk_bf16_f32 v51, v38, v39
    v_cvt_pk_bf16_f32 v52, v40, v41
    v_cvt_pk_bf16_f32 v53, v42, v43
    v_cvt_pk_bf16_f32 v54, v44, v45
    v_cvt_pk_bf16_f32 v55, v46, v47
    v_lshlrev_b32 v32, 16, v48
    v_and_b32 v33, 0xffff0000, v48
    v_lshlrev_b32 v34, 16, v49
    v_and_b32 v35, 0xffff0000, v49
    v_lshlrev_b32 v36, 16, v50
    v_and_b32 v37, 0xffff0000, v50
    v_lshlrev_b32 v38, 16, v51
    v_and_b32 v39, 0xffff0000, v51
    v_lshlrev_b32 v40, 16, v52
    v_and_b32 v41, 0xffff0000, v52
    v_lshlrev_b32 v42, 16, v53
    v_and_b32 v43, 0xffff0000, v53
    v_lshlrev_b32 v44, 16, v54
    v_and_b32 v45, 0xffff0000, v54
    v_lshlrev_b32 v46, 16, v55
    v_and_b32 v47, 0xffff0000, v55
    v_mul_f32 v32, v61, v32
    v_mul_f32 v33, v61, v33
    v_mul_f32 v34, v61, v34
    v_mul_f32 v35, v61, v35
    v_mul_f32 v36, v61, v36
    v_mul_f32 v37, v61, v37
    v_mul_f32 v38, v61, v38
    v_mul_f32 v39, v61, v39
    v_mul_f32 v40, v61, v40
    v_mul_f32 v41, v61, v41
    v_mul_f32 v42, v61, v42
    v_mul_f32 v43, v61, v43
    v_mul_f32 v44, v61, v44
    v_mul_f32 v45, v61, v45
    v_mul_f32 v46, v61, v46
    v_mul_f32 v47, v61, v47
    v_cvt_pk_bf16_f32 v48, v32, v33
    v_cvt_pk_bf16_f32 v49, v34, v35
    v_cvt_pk_bf16_f32 v50, v36, v37
    v_cvt_pk_bf16_f32 v51, v38, v39
    v_cvt_pk_bf16_f32 v52, v40, v41
    v_cvt_pk_bf16_f32 v53, v42, v43
    v_cvt_pk_bf16_f32 v54, v44, v45
    v_cvt_pk_bf16_f32 v55, v46, v47
    ds_bpermute_b32 v16, v97, v48 offset:0
    ds_bpermute_b32 v17, v97, v49 offset:0
    ds_bpermute_b32 v18, v97, v50 offset:0
    ds_bpermute_b32 v19, v97, v51 offset:0
    ds_bpermute_b32 v20, v97, v52 offset:0
    ds_bpermute_b32 v21, v97, v53 offset:0
    ds_bpermute_b32 v22, v97, v54 offset:0
    ds_bpermute_b32 v23, v97, v55 offset:0
    s_waitcnt lgkmcnt(0)
    ds_bpermute_b32 v24, v97, v48 offset:128
    ds_bpermute_b32 v25, v97, v49 offset:128
    ds_bpermute_b32 v26, v97, v50 offset:128
    ds_bpermute_b32 v27, v97, v51 offset:128
    ds_bpermute_b32 v28, v97, v52 offset:128
    ds_bpermute_b32 v29, v97, v53 offset:128
    ds_bpermute_b32 v30, v97, v54 offset:128
    ds_bpermute_b32 v31, v97, v55 offset:128
    s_mul_i32 s36, s39, 0x9E3779B1
    s_add_u32 s36, s36, 0x7F4A7C15
    s_waitcnt vmcnt(14) lgkmcnt(0)
    v_perm_b32 v64, v132, v128, s34
    v_perm_b32 v65, v132, v128, s35
    v_perm_b32 v66, v133, v129, s34
    v_perm_b32 v67, v133, v129, s35
    v_perm_b32 v68, v134, v130, s34
    v_perm_b32 v69, v134, v130, s35
    v_perm_b32 v70, v135, v131, s34
    v_perm_b32 v71, v135, v131, s35
    v_dot2_f32_bf16 v80, v64, v16, 0
    v_dot2_f32_bf16 v81, v65, v16, 0
    v_dot2_f32_bf16 v82, v66, v16, 0
    v_dot2_f32_bf16 v83, v67, v16, 0
    v_dot2_f32_bf16 v84, v68, v16, 0
    v_dot2_f32_bf16 v85, v69, v16, 0
    v_dot2_f32_bf16 v86, v70, v16, 0
    v_dot2_f32_bf16 v87, v71, v16, 0
    v_dot2_f32_bf16 v88, v64, v24, 0
    v_dot2_f32_bf16 v89, v65, v24, 0
    v_dot2_f32_bf16 v90, v66, v24, 0
    v_dot2_f32_bf16 v91, v67, v24, 0
    v_dot2_f32_bf16 v92, v68, v24, 0
    v_dot2_f32_bf16 v93, v69, v24, 0
    v_dot2_f32_bf16 v94, v70, v24, 0
    v_dot2_f32_bf16 v95, v71, v24, 0
    s_waitcnt vmcnt(12)
    v_perm_b32 v72, v140, v136, s34
    v_perm_b32 v73, v140, v136, s35
    v_perm_b32 v74, v141, v137, s34
    v_perm_b32 v75, v141, v137, s35
    v_perm_b32 v76, v142, v138, s34
    v_perm_b32 v77, v142, v138, s35
    v_perm_b32 v78, v143, v139, s34
    v_perm_b32 v79, v143, v139, s35
    v_dot2c_f32_bf16 v80, v72, v17
    v_dot2c_f32_bf16 v81, v73, v17
    v_dot2c_f32_bf16 v82, v74, v17
    v_dot2c_f32_bf16 v83, v75, v17
    v_dot2c_f32_bf16 v84, v76, v17
    v_dot2c_f32_bf16 v85, v77, v17
    v_dot2c_f32_bf16 v86, v78, v17
    v_dot2c_f32_bf16 v87, v79, v17
    v_dot2c_f32_bf16 v88, v72, v25
    v_dot2c_f32_bf16 v89, v73, v25
    v_dot2c_f32_bf16 v90, v74, v25
    v_dot2c_f32_bf16 v91, v75, v25
    v_dot2c_f32_bf16 v92, v76, v25
    v_dot2c_f32_bf16 v93, v77, v25
    v_dot2c_f32_bf16 v94, v78, v25
    v_dot2c_f32_bf16 v95, v79, v25
    s_waitcnt vmcnt(10)
    v_perm_b32 v64, v148, v144, s34
    v_perm_b32 v65, v148, v144, s35
    v_perm_b32 v66, v149, v145, s34
    v_perm_b32 v67, v149, v145, s35
    v_perm_b32 v68, v150, v146, s34
    v_perm_b32 v69, v150, v146, s35
    v_perm_b32 v70, v151, v147, s34
    v_perm_b32 v71, v151, v147, s35
    v_dot2c_f32_bf16 v80, v64, v18
    v_dot2c_f32_bf16 v81, v65, v18
    v_dot2c_f32_bf16 v82, v66, v18
    v_dot2c_f32_bf16 v83, v67, v18
    v_dot2c_f32_bf16 v84, v68, v18
    v_dot2c_f32_bf16 v85, v69, v18
    v_dot2c_f32_bf16 v86, v70, v18
    v_dot2c_f32_bf16 v87, v71, v18
    v_dot2c_f32_bf16 v88, v64, v26
    v_dot2c_f32_bf16 v89, v65, v26
    v_dot2c_f32_bf16 v90, v66, v26
    v_dot2c_f32_bf16 v91, v67, v26
    v_dot2c_f32_bf16 v92, v68, v26
    v_dot2c_f32_bf16 v93, v69, v26
    v_dot2c_f32_bf16 v94, v70, v26
    v_dot2c_f32_bf16 v95, v71, v26
    s_waitcnt vmcnt(8)
    v_perm_b32 v72, v156, v152, s34
    v_perm_b32 v73, v156, v152, s35
    v_perm_b32 v74, v157, v153, s34
    v_perm_b32 v75, v157, v153, s35
    v_perm_b32 v76, v158, v154, s34
    v_perm_b32 v77, v158, v154, s35
    v_perm_b32 v78, v159, v155, s34
    v_perm_b32 v79, v159, v155, s35
    v_dot2c_f32_bf16 v80, v72, v19
    v_dot2c_f32_bf16 v81, v73, v19
    v_dot2c_f32_bf16 v82, v74, v19
    v_dot2c_f32_bf16 v83, v75, v19
    v_dot2c_f32_bf16 v84, v76, v19
    v_dot2c_f32_bf16 v85, v77, v19
    v_dot2c_f32_bf16 v86, v78, v19
    v_dot2c_f32_bf16 v87, v79, v19
    v_dot2c_f32_bf16 v88, v72, v27
    v_dot2c_f32_bf16 v89, v73, v27
    v_dot2c_f32_bf16 v90, v74, v27
    v_dot2c_f32_bf16 v91, v75, v27
    v_dot2c_f32_bf16 v92, v76, v27
    v_dot2c_f32_bf16 v93, v77, v27
    v_dot2c_f32_bf16 v94, v78, v27
    v_dot2c_f32_bf16 v95, v79, v27
    s_waitcnt vmcnt(6)
    v_perm_b32 v64, v164, v160, s34
    v_perm_b32 v65, v164, v160, s35
    v_perm_b32 v66, v165, v161, s34
    v_perm_b32 v67, v165, v161, s35
    v_perm_b32 v68, v166, v162, s34
    v_perm_b32 v69, v166, v162, s35
    v_perm_b32 v70, v167, v163, s34
    v_perm_b32 v71, v167, v163, s35
    v_dot2c_f32_bf16 v80, v64, v20
    v_dot2c_f32_bf16 v81, v65, v20
    v_dot2c_f32_bf16 v82, v66, v20
    v_dot2c_f32_bf16 v83, v67, v20
    v_dot2c_f32_bf16 v84, v68, v20
    v_dot2c_f32_bf16 v85, v69, v20
    v_dot2c_f32_bf16 v86, v70, v20
    v_dot2c_f32_bf16 v87, v71, v20
    v_dot2c_f32_bf16 v88, v64, v28
    v_dot2c_f32_bf16 v89, v65, v28
    v_dot2c_f32_bf16 v90, v66, v28
    v_dot2c_f32_bf16 v91, v67, v28
    v_dot2c_f32_bf16 v92, v68, v28
    v_dot2c_f32_bf16 v93, v69, v28
    v_dot2c_f32_bf16 v94, v70, v28
    v_dot2c_f32_bf16 v95, v71, v28
    s_waitcnt vmcnt(4)
    v_perm_b32 v72, v172, v168, s34
    v_perm_b32 v73, v172, v168, s35
    v_perm_b32 v74, v173, v169, s34
    v_perm_b32 v75, v173, v169, s35
    v_perm_b32 v76, v174, v170, s34
    v_perm_b32 v77, v174, v170, s35
    v_perm_b32 v78, v175, v171, s34
    v_perm_b32 v79, v175, v171, s35
    v_dot2c_f32_bf16 v80, v72, v21
    v_dot2c_f32_bf16 v81, v73, v21
    v_dot2c_f32_bf16 v82, v74, v21
    v_dot2c_f32_bf16 v83, v75, v21
    v_dot2c_f32_bf16 v84, v76, v21
    v_dot2c_f32_bf16 v85, v77, v21
    v_dot2c_f32_bf16 v86, v78, v21
    v_dot2c_f32_bf16 v87, v79, v21
    v_dot2c_f32_bf16 v88, v72, v29
    v_dot2c_f32_bf16 v89, v73, v29
    v_dot2c_f32_bf16 v90, v74, v29
    v_dot2c_f32_bf16 v91, v75, v29
    v_dot2c_f32_bf16 v92, v76, v29
    v_dot2c_f32_bf16 v93, v77, v29
    v_dot2c_f32_bf16 v94, v78, v29
    v_dot2c_f32_bf16 v95, v79, v29
    s_waitcnt vmcnt(2)
    v_perm_b32 v64, v180, v176, s34
    v_perm_b32 v65, v180, v176, s35
    v_perm_b32 v66, v181, v177, s34
    v_perm_b32 v67, v181, v177, s35
    v_perm_b32 v68, v182, v178, s34
    v_perm_b32 v69, v182, v178, s35
    v_perm_b32 v70, v183, v179, s34
    v_perm_b32 v71, v183, v179, s35
    v_dot2c_f32_bf16 v80, v64, v22
    v_dot2c_f32_bf16 v81, v65, v22
    v_dot2c_f32_bf16 v82, v66, v22
    v_dot2c_f32_bf16 v83, v67, v22
    v_dot2c_f32_bf16 v84, v68, v22
    v_dot2c_f32_bf16 v85, v69, v22
    v_dot2c_f32_bf16 v86, v70, v22
    v_dot2c_f32_bf16 v87, v71, v22
    v_dot2c_f32_bf16 v88, v64, v30
    v_dot2c_f32_bf16 v89, v65, v30
    v_dot2c_f32_bf16 v90, v66, v30
    v_dot2c_f32_bf16 v91, v67, v30
    v_dot2c_f32_bf16 v92, v68, v30
    v_dot2c_f32_bf16 v93, v69, v30
    v_dot2c_f32_bf16 v94, v70, v30
    v_dot2c_f32_bf16 v95, v71, v30
    s_waitcnt vmcnt(0)
    v_perm_b32 v72, v188, v184, s34
    v_perm_b32 v73, v188, v184, s35
    v_perm_b32 v74, v189, v185, s34
    v_perm_b32 v75, v189, v185, s35
    v_perm_b32 v76, v190, v186, s34
    v_perm_b32 v77, v190, v186, s35
    v_perm_b32 v78, v191, v187, s34
    v_perm_b32 v79, v191, v187, s35
    v_dot2c_f32_bf16 v80, v72, v23
    v_dot2c_f32_bf16 v81, v73, v23
    v_dot2c_f32_bf16 v82, v74, v23
    v_dot2c_f32_bf16 v83, v75, v23
    v_dot2c_f32_bf16 v84, v76, v23
    v_dot2c_f32_bf16 v85, v77, v23
    v_dot2c_f32_bf16 v86, v78, v23
    v_dot2c_f32_bf16 v87, v79, v23
    v_dot2c_f32_bf16 v88, v72, v31
    v_dot2c_f32_bf16 v89, v73, v31
    v_dot2c_f32_bf16 v90, v74, v31
    v_dot2c_f32_bf16 v91, v75, v31
    v_dot2c_f32_bf16 v92, v76, v31
    v_dot2c_f32_bf16 v93, v77, v31
    v_dot2c_f32_bf16 v94, v78, v31
    v_dot2c_f32_bf16 v95, v79, v31
    v_permlane32_swap_b32 v80, v88
    v_permlane32_swap_b32 v81, v89
    v_permlane32_swap_b32 v82, v90
    v_permlane32_swap_b32 v83, v91
    v_permlane32_swap_b32 v84, v92
    v_permlane32_swap_b32 v85, v93
    v_permlane32_swap_b32 v86, v94
    v_permlane32_swap_b32 v87, v95
    v_pk_add_f32 v[80:81], v[80:81], v[88:89]
    v_pk_add_f32 v[82:83], v[82:83], v[90:91]
    v_pk_add_f32 v[84:85], v[84:85], v[92:93]
    v_pk_add_f32 v[86:87], v[86:87], v[94:95]
    s_nop 0
    v_permlane16_swap_b32 v80, v84
    v_permlane16_swap_b32 v81, v85
    v_permlane16_swap_b32 v82, v86
    v_permlane16_swap_b32 v83, v87
    v_pk_add_f32 v[80:81], v[80:81], v[84:85]
    v_pk_add_f32 v[82:83], v[82:83], v[86:87]
    s_nop 0
    v_add_f32_dpp v80, v80, v80 row_ror:8 row_mask:0xf bank_mask:0xf
    v_add_f32_dpp v81, v81, v81 row_ror:8 row_mask:0xf bank_mask:0xf
    v_add_f32_dpp v82, v82, v82 row_ror:8 row_mask:0xf bank_mask:0xf
    v_add_f32_dpp v83, v83, v83 row_ror:8 row_mask:0xf bank_mask:0xf
    s_mov_b32 exec_lo, 0x00ff00ff
    s_mov_b32 exec_hi, 0x00ff00ff
    ds_write_b128 v120, v[80:83] offset:34304
    s_mov_b64 exec, 1
    ds_add_rtn_u32 v64, v101, v121 offset:33028
    s_waitcnt lgkmcnt(0)
    v_readfirstlane_b32 s4, v64
    s_mov_b64 exec, -1
    s_cmp_lg_u32 s4, 3
    s_cbranch_scc1 L_join
    s_mov_b32 exec_hi, 0
    ds_read_b128 v[64:67], v122 offset:34304
    ds_read_b128 v[68:71], v122 offset:34816
    ds_read_b128 v[72:75], v122 offset:35328
    ds_read_b128 v[76:79], v122 offset:35840
    s_waitcnt lgkmcnt(0)
    v_pk_add_f32 v[64:65], v[64:65], v[68:69]
    v_pk_add_f32 v[72:73], v[72:73], v[76:77]
    v_pk_add_f32 v[66:67], v[66:67], v[70:71]
    v_pk_add_f32 v[74:75], v[74:75], v[78:79]
    v_pk_add_f32 v[64:65], v[64:65], v[72:73]
    v_pk_add_f32 v[66:67], v[66:67], v[74:75]
    v_cvt_pk_bf16_f32 v64, v64, v65
    v_cvt_pk_bf16_f32 v66, v66, v67
    v_mov_b32 v65, s36
    v_mov_b32 v67, s36
    v_lshl_add_u32 v68, v125, 11, v126
    s_lshr_b32 s4, s96, 3
    s_lshl_b32 s4, s4, 12
    s_and_b32 s5, s96, 7
    s_lshl_b32 s5, s5, 8
    s_add_u32 s4, s4, s5
    s_add_u32 s4, s4, 4096
    buffer_store_dwordx4 v[64:67], v68, s[48:51], s4 offen sc1
    s_branch L_join
L_role_h:
    s_mov_b32 s56, s84
    s_mov_b32 s57, s85
    s_mov_b32 s58, 1835008
    s_mov_b32 s59, 0x00020000
    s_mov_b32 s60, s86
    s_mov_b32 s61, s87
    s_mov_b32 s62, 3584
    s_mov_b32 s63, 0x00020000
    s_sub_u32 s96, s2, 64
    v_mul_u32_u24 v98, 57344, v1
    s_mul_i32 s4, s37, 458752
    v_lshl_add_u32 v98, v14, 4, v98
    s_lshl_b32 s5, s96, 7
    s_add_u32 s4, s4, s5
    v_lshlrev_b32 v15, 5, v0
    v_and_b32 v99, 15, v0
    v_lshlrev_b32 v99, 3, v99
    buffer_load_dwordx2 v[102:103], v99, s[60:63], s5 offen
    buffer_load_dwordx4 v[2:5], v15, s[52:55], 0 offen
    buffer_load_dwordx4 v[6:9], v15, s[52:55], 0 offen offset:16
    buffer_load_dwordx4 v[128:131], v98, s[56:59], s4 offen nt
    s_add_u32 s4, s4, 3584
    buffer_load_dwordx4 v[132:135], v98, s[56:59], s4 offen nt
    s_add_u32 s4, s4, 3584
    buffer_load_dwordx4 v[136:139], v98, s[56:59], s4 offen nt
    s_add_u32 s4, s4, 3584
    buffer_load_dwordx4 v[140:143], v98, s[56:59], s4 offen nt
    s_add_u32 s4, s4, 3584
    buffer_load_dwordx4 v[144:147], v98, s[56:59], s4 offen nt
    s_add_u32 s4, s4, 3584
    buffer_load_dwordx4 v[148:151], v98, s[56:59], s4 offen nt
    s_add_u32 s4, s4, 3584
    buffer_load_dwordx4 v[152:155], v98, s[56:59], s4 offen nt
    s_add_u32 s4, s4, 3584
    buffer_load_dwordx4 v[156:159], v98, s[56:59], s4 offen nt
    s_add_u32 s4, s4, 3584
    buffer_load_dwordx4 v[160:163], v98, s[56:59], s4 offen nt
    s_add_u32 s4, s4, 3584
    buffer_load_dwordx4 v[164:167], v98, s[56:59], s4 offen nt
    s_add_u32 s4, s4, 3584
    buffer_load_dwordx4 v[168:171], v98, s[56:59], s4 offen nt
    s_add_u32 s4, s4, 3584
    buffer_load_dwordx4 v[172:175], v98, s[56:59], s4 offen nt
    s_add_u32 s4, s4, 3584
    buffer_load_dwordx4 v[176:179], v98, s[56:59], s4 offen nt
    s_add_u32 s4, s4, 3584
    buffer_load_dwordx4 v[180:183], v98, s[56:59], s4 offen nt
    s_add_u32 s4, s4, 3584
    buffer_load_dwordx4 v[184:187], v98, s[56:59], s4 offen nt
    s_add_u32 s4, s4, 3584
    buffer_load_dwordx4 v[188:191], v98, s[56:59], s4 offen nt
    s_waitcnt lgkmcnt(0)
    s_load_dword s39, s[48:49], 4
    s_barrier
    v_lshrrev_b32 v120, 5, v0
    v_lshlrev_b32 v120, 8, v120
    v_bfe_u32 v123, v0, 4, 1
    v_lshl_add_u32 v120, v123, 4, v120
    v_and_b32 v123, 7, v0
    v_lshl_add_u32 v120, v123, 5, v120
    s_lshl_b32 s5, s37, 9
    v_add_u32 v120, s5, v120
    v_lshlrev_b32 v122, 4, v0
    v_mov_b32 v121, 1
    v_mov_b32 v101, 0
    s_lshl_b32 s4, s37, 5
    v_lshl_add_u32 v97, v1, 2, s4
    v_lshrrev_b32 v125, 4, v0
    v_and_b32 v126, 15, v0
    v_lshlrev_b32 v126, 4, v126
    s_waitcnt vmcnt(16)
    v_lshlrev_b32 v32, 16, v2
    v_and_b32 v33, 0xffff0000, v2
    v_lshlrev_b32 v34, 16, v3
    v_and_b32 v35, 0xffff0000, v3
    v_lshlrev_b32 v36, 16, v4
    v_and_b32 v37, 0xffff0000, v4
    v_lshlrev_b32 v38, 16, v5
    v_and_b32 v39, 0xffff0000, v5
    v_lshlrev_b32 v40, 16, v6
    v_and_b32 v41, 0xffff0000, v6
    v_lshlrev_b32 v42, 16, v7
    v_and_b32 v43, 0xffff0000, v7
    v_lshlrev_b32 v44, 16, v8
    v_and_b32 v45, 0xffff0000, v8
    v_lshlrev_b32 v46, 16, v9
    v_and_b32 v47, 0xffff0000, v9
    v_pk_add_f32 v[64:65], v[32:33], v[34:35]
    v_pk_add_f32 v[66:67], v[36:37], v[38:39]
    v_pk_add_f32 v[68:69], v[40:41], v[42:43]
    v_pk_add_f32 v[70:71], v[44:45], v[46:47]
    v_pk_add_f32 v[64:65], v[64:65], v[66:67]
    v_pk_add_f32 v[68:69], v[68:69], v[70:71]
    v_pk_add_f32 v[64:65], v[64:65], v[68:69]
    v_add_f32 v60, v64, v65
    s_nop 1
    v_add_f32_dpp v60, v60, v60 row_ror:8 row_mask:0xf bank_mask:0xf
    s_nop 1
    v_add_f32_dpp v60, v60, v60 row_ror:4 row_mask:0xf bank_mask:0xf
    s_nop 1
    v_add_f32_dpp v60, v60, v60 row_ror:2 row_mask:0xf bank_mask:0xf
    s_nop 1
    v_add_f32_dpp v60, v60, v60 row_ror:1 row_mask:0xf bank_mask:0xf
    v_mov_b32 v64, v60
    s_nop 1
    v_permlane16_swap_b32 v60, v64
    v_add_f32 v60, v60, v64
    v_mul_f32 v60, 0x3b000000, v60
    v_mov_b32 v65, v60
    v_mov_b32 v64, v60
    v_pk_add_f32 v[72:73], v[32:33], v[64:65] neg_lo:[0,1] neg_hi:[0,1]
    v_pk_add_f32 v[74:75], v[34:35], v[64:65] neg_lo:[0,1] neg_hi:[0,1]
    v_pk_add_f32 v[76:77], v[36:37], v[64:65] neg_lo:[0,1] neg_hi:[0,1]
    v_pk_add_f32 v[78:79], v[38:39], v[64:65] neg_lo:[0,1] neg_hi:[0,1]
    v_pk_add_f32 v[80:81], v[40:41], v[64:65] neg_lo:[0,1] neg_hi:[0,1]
    v_pk_add_f32 v[82:83], v[42:43], v[64:65] neg_lo:[0,1] neg_hi:[0,1]
    v_pk_add_f32 v[84:85], v[44:45], v[64:65] neg_lo:[0,1] neg_hi:[0,1]
    v_pk_add_f32 v[86:87], v[46:47], v[64:65] neg_lo:[0,1] neg_hi:[0,1]
    v_pk_mul_f32 v[72:73], v[72:73], v[72:73]
    v_pk_mul_f32 v[74:75], v[74:75], v[74:75]
    v_pk_mul_f32 v[76:77], v[76:77], v[76:77]
    v_pk_mul_f32 v[78:79], v[78:79], v[78:79]
    v_pk_mul_f32 v[80:81], v[80:81], v[80:81]
    v_pk_mul_f32 v[82:83], v[82:83], v[82:83]
    v_pk_mul_f32 v[84:85], v[84:85], v[84:85]
    v_pk_mul_f32 v[86:87], v[86:87], v[86:87]
    v_pk_add_f32 v[64:65], v[72:73], v[74:75]
    v_pk_add_f32 v[66:67], v[76:77], v[78:79]
    v_pk_add_f32 v[68:69], v[80:81], v[82:83]
    v_pk_add_f32 v[70:71], v[84:85], v[86:87]
    v_pk_add_f32 v[64:65], v[64:65], v[66:67]
    v_pk_add_f32 v[68:69], v[68:69], v[70:71]
    v_pk_add_f32 v[64:65], v[64:65], v[68:69]
    v_add_f32 v61, v64, v65
    s_nop 1
    v_add_f32_dpp v61, v61, v61 row_ror:8 row_mask:0xf bank_mask:0xf
    s_nop 1
    v_add_f32_dpp v61, v61, v61 row_ror:4 row_mask:0xf bank_mask:0xf
    s_nop 1
    v_add_f32_dpp v61, v61, v61 row_ror:2 row_mask:0xf bank_mask:0xf
    s_nop 1
    v_add_f32_dpp v61, v61, v61 row_ror:1 row_mask:0xf bank_mask:0xf
    v_mov_b32 v64, v61
    s_nop 1
    v_permlane16_swap_b32 v61, v64
    v_add_f32 v61, v61, v64
    v_mul_f32 v61, 0x3b000000, v61
    v_cvt_pk_bf16_f32 v60, v60, v60
    v_and_b32 v60, 0xffff0000, v60
    v_cvt_pk_bf16_f32 v61, v61, v61
    v_and_b32 v61, 0xffff0000, v61
    v_add_f32 v61, 0x3727c5ac, v61
    v_cvt_pk_bf16_f32 v61, v61, v61
    v_and_b32 v61, 0xffff0000, v61
    v_sqrt_f32 v61, v61
    s_nop 0
    v_cvt_pk_bf16_f32 v61, v61, v61
    v_and_b32 v61, 0xffff0000, v61
    v_rcp_f32 v61, v61
    v_sub_f32 v32, v32, v60
    v_sub_f32 v33, v33, v60
    v_sub_f32 v34, v34, v60
    v_sub_f32 v35, v35, v60
    v_sub_f32 v36, v36, v60
    v_sub_f32 v37, v37, v60
    v_sub_f32 v38, v38, v60
    v_sub_f32 v39, v39, v60
    v_sub_f32 v40, v40, v60
    v_sub_f32 v41, v41, v60
    v_sub_f32 v42, v42, v60
    v_sub_f32 v43, v43, v60
    v_sub_f32 v44, v44, v60
    v_sub_f32 v45, v45, v60
    v_sub_f32 v46, v46, v60
    v_sub_f32 v47, v47, v60
    v_cvt_pk_bf16_f32 v48, v32, v33
    v_cvt_pk_bf16_f32 v49, v34, v35
    v_cvt_pk_bf16_f32 v50, v36, v37
    v_cvt_pk_bf16_f32 v51, v38, v39
    v_cvt_pk_bf16_f32 v52, v40, v41
    v_cvt_pk_bf16_f32 v53, v42, v43
    v_cvt_pk_bf16_f32 v54, v44, v45
    v_cvt_pk_bf16_f32 v55, v46, v47
    v_lshlrev_b32 v32, 16, v48
    v_and_b32 v33, 0xffff0000, v48
    v_lshlrev_b32 v34, 16, v49
    v_and_b32 v35, 0xffff0000, v49
    v_lshlrev_b32 v36, 16, v50
    v_and_b32 v37, 0xffff0000, v50
    v_lshlrev_b32 v38, 16, v51
    v_and_b32 v39, 0xffff0000, v51
    v_lshlrev_b32 v40, 16, v52
    v_and_b32 v41, 0xffff0000, v52
    v_lshlrev_b32 v42, 16, v53
    v_and_b32 v43, 0xffff0000, v53
    v_lshlrev_b32 v44, 16, v54
    v_and_b32 v45, 0xffff0000, v54
    v_lshlrev_b32 v46, 16, v55
    v_and_b32 v47, 0xffff0000, v55
    v_mul_f32 v32, v61, v32
    v_mul_f32 v33, v61, v33
    v_mul_f32 v34, v61, v34
    v_mul_f32 v35, v61, v35
    v_mul_f32 v36, v61, v36
    v_mul_f32 v37, v61, v37
    v_mul_f32 v38, v61, v38
    v_mul_f32 v39, v61, v39
    v_mul_f32 v40, v61, v40
    v_mul_f32 v41, v61, v41
    v_mul_f32 v42, v61, v42
    v_mul_f32 v43, v61, v43
    v_mul_f32 v44, v61, v44
    v_mul_f32 v45, v61, v45
    v_mul_f32 v46, v61, v46
    v_mul_f32 v47, v61, v47
    v_cvt_pk_bf16_f32 v48, v32, v33
    v_cvt_pk_bf16_f32 v49, v34, v35
    v_cvt_pk_bf16_f32 v50, v36, v37
    v_cvt_pk_bf16_f32 v51, v38, v39
    v_cvt_pk_bf16_f32 v52, v40, v41
    v_cvt_pk_bf16_f32 v53, v42, v43
    v_cvt_pk_bf16_f32 v54, v44, v45
    v_cvt_pk_bf16_f32 v55, v46, v47
    v_lshlrev_b32 v32, 16, v48
    v_and_b32 v33, 0xffff0000, v48
    v_lshlrev_b32 v34, 16, v49
    v_and_b32 v35, 0xffff0000, v49
    v_lshlrev_b32 v36, 16, v50
    v_and_b32 v37, 0xffff0000, v50
    v_lshlrev_b32 v38, 16, v51
    v_and_b32 v39, 0xffff0000, v51
    v_lshlrev_b32 v40, 16, v52
    v_and_b32 v41, 0xffff0000, v52
    v_lshlrev_b32 v42, 16, v53
    v_and_b32 v43, 0xffff0000, v53
    v_lshlrev_b32 v44, 16, v54
    v_and_b32 v45, 0xffff0000, v54
    v_lshlrev_b32 v46, 16, v55
    v_and_b32 v47, 0xffff0000, v55
    v_pk_add_f32 v[64:65], v[32:33], v[34:35]
    v_pk_add_f32 v[66:67], v[36:37], v[38:39]
    v_pk_add_f32 v[68:69], v[40:41], v[42:43]
    v_pk_add_f32 v[70:71], v[44:45], v[46:47]
    v_pk_add_f32 v[64:65], v[64:65], v[66:67]
    v_pk_add_f32 v[68:69], v[68:69], v[70:71]
    v_pk_add_f32 v[64:65], v[64:65], v[68:69]
    v_add_f32 v60, v64, v65
    s_nop 1
    v_add_f32_dpp v60, v60, v60 row_ror:8 row_mask:0xf bank_mask:0xf
    s_nop 1
    v_add_f32_dpp v60, v60, v60 row_ror:4 row_mask:0xf bank_mask:0xf
    s_nop 1
    v_add_f32_dpp v60, v60, v60 row_ror:2 row_mask:0xf bank_mask:0xf
    s_nop 1
    v_add_f32_dpp v60, v60, v60 row_ror:1 row_mask:0xf bank_mask:0xf
    v_mov_b32 v64, v60
    s_nop 1
    v_permlane16_swap_b32 v60, v64
    v_add_f32 v60, v60, v64
    v_mul_f32 v60, 0x3b000000, v60
    v_mov_b32 v65, v60
    v_mov_b32 v64, v60
    v_pk_add_f32 v[72:73], v[32:33], v[64:65] neg_lo:[0,1] neg_hi:[0,1]
    v_pk_add_f32 v[74:75], v[34:35], v[64:65] neg_lo:[0,1] neg_hi:[0,1]
    v_pk_add_f32 v[76:77], v[36:37], v[64:65] neg_lo:[0,1] neg_hi:[0,1]
    v_pk_add_f32 v[78:79], v[38:39], v[64:65] neg_lo:[0,1] neg_hi:[0,1]
    v_pk_add_f32 v[80:81], v[40:41], v[64:65] neg_lo:[0,1] neg_hi:[0,1]
    v_pk_add_f32 v[82:83], v[42:43], v[64:65] neg_lo:[0,1] neg_hi:[0,1]
    v_pk_add_f32 v[84:85], v[44:45], v[64:65] neg_lo:[0,1] neg_hi:[0,1]
    v_pk_add_f32 v[86:87], v[46:47], v[64:65] neg_lo:[0,1] neg_hi:[0,1]
    v_pk_mul_f32 v[72:73], v[72:73], v[72:73]
    v_pk_mul_f32 v[74:75], v[74:75], v[74:75]
    v_pk_mul_f32 v[76:77], v[76:77], v[76:77]
    v_pk_mul_f32 v[78:79], v[78:79], v[78:79]
    v_pk_mul_f32 v[80:81], v[80:81], v[80:81]
    v_pk_mul_f32 v[82:83], v[82:83], v[82:83]
    v_pk_mul_f32 v[84:85], v[84:85], v[84:85]
    v_pk_mul_f32 v[86:87], v[86:87], v[86:87]
    v_pk_add_f32 v[64:65], v[72:73], v[74:75]
    v_pk_add_f32 v[66:67], v[76:77], v[78:79]
    v_pk_add_f32 v[68:69], v[80:81], v[82:83]
    v_pk_add_f32 v[70:71], v[84:85], v[86:87]
    v_pk_add_f32 v[64:65], v[64:65], v[66:67]
    v_pk_add_f32 v[68:69], v[68:69], v[70:71]
    v_pk_add_f32 v[64:65], v[64:65], v[68:69]
    v_add_f32 v61, v64, v65
    s_nop 1
    v_add_f32_dpp v61, v61, v61 row_ror:8 row_mask:0xf bank_mask:0xf
    s_nop 1
    v_add_f32_dpp v61, v61, v61 row_ror:4 row_mask:0xf bank_mask:0xf
    s_nop 1
    v_add_f32_dpp v61, v61, v61 row_ror:2 row_mask:0xf bank_mask:0xf
    s_nop 1
    v_add_f32_dpp v61, v61, v61 row_ror:1 row_mask:0xf bank_mask:0xf
    v_mov_b32 v64, v61
    s_nop 1
    v_permlane16_swap_b32 v61, v64
    v_add_f32 v61, v61, v64
    v_mul_f32 v61, 0x3b000000, v61
    v_cvt_pk_bf16_f32 v60, v60, v60
    v_and_b32 v60, 0xffff0000, v60
    v_cvt_pk_bf16_f32 v61, v61, v61
    v_and_b32 v61, 0xffff0000, v61
    v_add_f32 v61, 0x3727c5ac, v61
    v_cvt_pk_bf16_f32 v61, v61, v61
    v_and_b32 v61, 0xffff0000, v61
    v_sqrt_f32 v61, v61
    s_nop 0
    v_cvt_pk_bf16_f32 v61, v61, v61
    v_and_b32 v61, 0xffff0000, v61
    v_rcp_f32 v61, v61
    v_sub_f32 v32, v32, v60
    v_sub_f32 v33, v33, v60
    v_sub_f32 v34, v34, v60
    v_sub_f32 v35, v35, v60
    v_sub_f32 v36, v36, v60
    v_sub_f32 v37, v37, v60
    v_sub_f32 v38, v38, v60
    v_sub_f32 v39, v39, v60
    v_sub_f32 v40, v40, v60
    v_sub_f32 v41, v41, v60
    v_sub_f32 v42, v42, v60
    v_sub_f32 v43, v43, v60
    v_sub_f32 v44, v44, v60
    v_sub_f32 v45, v45, v60
    v_sub_f32 v46, v46, v60
    v_sub_f32 v47, v47, v60
    v_cvt_pk_bf16_f32 v48, v32, v33
    v_cvt_pk_bf16_f32 v49, v34, v35
    v_cvt_pk_bf16_f32 v50, v36, v37
    v_cvt_pk_bf16_f32 v51, v38, v39
    v_cvt_pk_bf16_f32 v52, v40, v41
    v_cvt_pk_bf16_f32 v53, v42, v43
    v_cvt_pk_bf16_f32 v54, v44, v45
    v_cvt_pk_bf16_f32 v55, v46, v47
    v_lshlrev_b32 v32, 16, v48
    v_and_b32 v33, 0xffff0000, v48
    v_lshlrev_b32 v34, 16, v49
    v_and_b32 v35, 0xffff0000, v49
    v_lshlrev_b32 v36, 16, v50
    v_and_b32 v37, 0xffff0000, v50
    v_lshlrev_b32 v38, 16, v51
    v_and_b32 v39, 0xffff0000, v51
    v_lshlrev_b32 v40, 16, v52
    v_and_b32 v41, 0xffff0000, v52
    v_lshlrev_b32 v42, 16, v53
    v_and_b32 v43, 0xffff0000, v53
    v_lshlrev_b32 v44, 16, v54
    v_and_b32 v45, 0xffff0000, v54
    v_lshlrev_b32 v46, 16, v55
    v_and_b32 v47, 0xffff0000, v55
    v_mul_f32 v32, v61, v32
    v_mul_f32 v33, v61, v33
    v_mul_f32 v34, v61, v34
    v_mul_f32 v35, v61, v35
    v_mul_f32 v36, v61, v36
    v_mul_f32 v37, v61, v37
    v_mul_f32 v38, v61, v38
    v_mul_f32 v39, v61, v39
    v_mul_f32 v40, v61, v40
    v_mul_f32 v41, v61, v41
    v_mul_f32 v42, v61, v42
    v_mul_f32 v43, v61, v43
    v_mul_f32 v44, v61, v44
    v_mul_f32 v45, v61, v45
    v_mul_f32 v46, v61, v46
    v_mul_f32 v47, v61, v47
    v_cvt_pk_bf16_f32 v48, v32, v33
    v_cvt_pk_bf16_f32 v49, v34, v35
    v_cvt_pk_bf16_f32 v50, v36, v37
    v_cvt_pk_bf16_f32 v51, v38, v39
    v_cvt_pk_bf16_f32 v52, v40, v41
    v_cvt_pk_bf16_f32 v53, v42, v43
    v_cvt_pk_bf16_f32 v54, v44, v45
    v_cvt_pk_bf16_f32 v55, v46, v47
    ds_bpermute_b32 v16, v97, v48 offset:0
    ds_bpermute_b32 v17, v97, v49 offset:0
    ds_bpermute_b32 v18, v97, v50 offset:0
    ds_bpermute_b32 v19, v97, v51 offset:0
    ds_bpermute_b32 v20, v97, v52 offset:0
    ds_bpermute_b32 v21, v97, v53 offset:0
    ds_bpermute_b32 v22, v97, v54 offset:0
    ds_bpermute_b32 v23, v97, v55 offset:0
    s_waitcnt lgkmcnt(0)
    ds_bpermute_b32 v24, v97, v48 offset:128
    ds_bpermute_b32 v25, v97, v49 offset:128
    ds_bpermute_b32 v26, v97, v50 offset:128
    ds_bpermute_b32 v27, v97, v51 offset:128
    ds_bpermute_b32 v28, v97, v52 offset:128
    ds_bpermute_b32 v29, v97, v53 offset:128
    ds_bpermute_b32 v30, v97, v54 offset:128
    ds_bpermute_b32 v31, v97, v55 offset:128
    s_mul_i32 s36, s39, 0x9E3779B1
    s_add_u32 s36, s36, 0x7F4A7C15
    s_waitcnt vmcnt(14) lgkmcnt(0)
    v_perm_b32 v64, v132, v128, s34
    v_perm_b32 v65, v132, v128, s35
    v_perm_b32 v66, v133, v129, s34
    v_perm_b32 v67, v133, v129, s35
    v_perm_b32 v68, v134, v130, s34
    v_perm_b32 v69, v134, v130, s35
    v_perm_b32 v70, v135, v131, s34
    v_perm_b32 v71, v135, v131, s35
    v_dot2_f32_bf16 v80, v64, v16, 0
    v_dot2_f32_bf16 v81, v65, v16, 0
    v_dot2_f32_bf16 v82, v66, v16, 0
    v_dot2_f32_bf16 v83, v67, v16, 0
    v_dot2_f32_bf16 v84, v68, v16, 0
    v_dot2_f32_bf16 v85, v69, v16, 0
    v_dot2_f32_bf16 v86, v70, v16, 0
    v_dot2_f32_bf16 v87, v71, v16, 0
    v_dot2_f32_bf16 v88, v64, v24, 0
    v_dot2_f32_bf16 v89, v65, v24, 0
    v_dot2_f32_bf16 v90, v66, v24, 0
    v_dot2_f32_bf16 v91, v67, v24, 0
    v_dot2_f32_bf16 v92, v68, v24, 0
    v_dot2_f32_bf16 v93, v69, v24, 0
    v_dot2_f32_bf16 v94, v70, v24, 0
    v_dot2_f32_bf16 v95, v71, v24, 0
    s_waitcnt vmcnt(12)
    v_perm_b32 v72, v140, v136, s34
    v_perm_b32 v73, v140, v136, s35
    v_perm_b32 v74, v141, v137, s34
    v_perm_b32 v75, v141, v137, s35
    v_perm_b32 v76, v142, v138, s34
    v_perm_b32 v77, v142, v138, s35
    v_perm_b32 v78, v143, v139, s34
    v_perm_b32 v79, v143, v139, s35
    v_dot2c_f32_bf16 v80, v72, v17
    v_dot2c_f32_bf16 v81, v73, v17
    v_dot2c_f32_bf16 v82, v74, v17
    v_dot2c_f32_bf16 v83, v75, v17
    v_dot2c_f32_bf16 v84, v76, v17
    v_dot2c_f32_bf16 v85, v77, v17
    v_dot2c_f32_bf16 v86, v78, v17
    v_dot2c_f32_bf16 v87, v79, v17
    v_dot2c_f32_bf16 v88, v72, v25
    v_dot2c_f32_bf16 v89, v73, v25
    v_dot2c_f32_bf16 v90, v74, v25
    v_dot2c_f32_bf16 v91, v75, v25
    v_dot2c_f32_bf16 v92, v76, v25
    v_dot2c_f32_bf16 v93, v77, v25
    v_dot2c_f32_bf16 v94, v78, v25
    v_dot2c_f32_bf16 v95, v79, v25
    s_waitcnt vmcnt(10)
    v_perm_b32 v64, v148, v144, s34
    v_perm_b32 v65, v148, v144, s35
    v_perm_b32 v66, v149, v145, s34
    v_perm_b32 v67, v149, v145, s35
    v_perm_b32 v68, v150, v146, s34
    v_perm_b32 v69, v150, v146, s35
    v_perm_b32 v70, v151, v147, s34
    v_perm_b32 v71, v151, v147, s35
    v_dot2c_f32_bf16 v80, v64, v18
    v_dot2c_f32_bf16 v81, v65, v18
    v_dot2c_f32_bf16 v82, v66, v18
    v_dot2c_f32_bf16 v83, v67, v18
    v_dot2c_f32_bf16 v84, v68, v18
    v_dot2c_f32_bf16 v85, v69, v18
    v_dot2c_f32_bf16 v86, v70, v18
    v_dot2c_f32_bf16 v87, v71, v18
    v_dot2c_f32_bf16 v88, v64, v26
    v_dot2c_f32_bf16 v89, v65, v26
    v_dot2c_f32_bf16 v90, v66, v26
    v_dot2c_f32_bf16 v91, v67, v26
    v_dot2c_f32_bf16 v92, v68, v26
    v_dot2c_f32_bf16 v93, v69, v26
    v_dot2c_f32_bf16 v94, v70, v26
    v_dot2c_f32_bf16 v95, v71, v26
    s_waitcnt vmcnt(8)
    v_perm_b32 v72, v156, v152, s34
    v_perm_b32 v73, v156, v152, s35
    v_perm_b32 v74, v157, v153, s34
    v_perm_b32 v75, v157, v153, s35
    v_perm_b32 v76, v158, v154, s34
    v_perm_b32 v77, v158, v154, s35
    v_perm_b32 v78, v159, v155, s34
    v_perm_b32 v79, v159, v155, s35
    v_dot2c_f32_bf16 v80, v72, v19
    v_dot2c_f32_bf16 v81, v73, v19
    v_dot2c_f32_bf16 v82, v74, v19
    v_dot2c_f32_bf16 v83, v75, v19
    v_dot2c_f32_bf16 v84, v76, v19
    v_dot2c_f32_bf16 v85, v77, v19
    v_dot2c_f32_bf16 v86, v78, v19
    v_dot2c_f32_bf16 v87, v79, v19
    v_dot2c_f32_bf16 v88, v72, v27
    v_dot2c_f32_bf16 v89, v73, v27
    v_dot2c_f32_bf16 v90, v74, v27
    v_dot2c_f32_bf16 v91, v75, v27
    v_dot2c_f32_bf16 v92, v76, v27
    v_dot2c_f32_bf16 v93, v77, v27
    v_dot2c_f32_bf16 v94, v78, v27
    v_dot2c_f32_bf16 v95, v79, v27
    s_waitcnt vmcnt(6)
    v_perm_b32 v64, v164, v160, s34
    v_perm_b32 v65, v164, v160, s35
    v_perm_b32 v66, v165, v161, s34
    v_perm_b32 v67, v165, v161, s35
    v_perm_b32 v68, v166, v162, s34
    v_perm_b32 v69, v166, v162, s35
    v_perm_b32 v70, v167, v163, s34
    v_perm_b32 v71, v167, v163, s35
    v_dot2c_f32_bf16 v80, v64, v20
    v_dot2c_f32_bf16 v81, v65, v20
    v_dot2c_f32_bf16 v82, v66, v20
    v_dot2c_f32_bf16 v83, v67, v20
    v_dot2c_f32_bf16 v84, v68, v20
    v_dot2c_f32_bf16 v85, v69, v20
    v_dot2c_f32_bf16 v86, v70, v20
    v_dot2c_f32_bf16 v87, v71, v20
    v_dot2c_f32_bf16 v88, v64, v28
    v_dot2c_f32_bf16 v89, v65, v28
    v_dot2c_f32_bf16 v90, v66, v28
    v_dot2c_f32_bf16 v91, v67, v28
    v_dot2c_f32_bf16 v92, v68, v28
    v_dot2c_f32_bf16 v93, v69, v28
    v_dot2c_f32_bf16 v94, v70, v28
    v_dot2c_f32_bf16 v95, v71, v28
    s_waitcnt vmcnt(4)
    v_perm_b32 v72, v172, v168, s34
    v_perm_b32 v73, v172, v168, s35
    v_perm_b32 v74, v173, v169, s34
    v_perm_b32 v75, v173, v169, s35
    v_perm_b32 v76, v174, v170, s34
    v_perm_b32 v77, v174, v170, s35
    v_perm_b32 v78, v175, v171, s34
    v_perm_b32 v79, v175, v171, s35
    v_dot2c_f32_bf16 v80, v72, v21
    v_dot2c_f32_bf16 v81, v73, v21
    v_dot2c_f32_bf16 v82, v74, v21
    v_dot2c_f32_bf16 v83, v75, v21
    v_dot2c_f32_bf16 v84, v76, v21
    v_dot2c_f32_bf16 v85, v77, v21
    v_dot2c_f32_bf16 v86, v78, v21
    v_dot2c_f32_bf16 v87, v79, v21
    v_dot2c_f32_bf16 v88, v72, v29
    v_dot2c_f32_bf16 v89, v73, v29
    v_dot2c_f32_bf16 v90, v74, v29
    v_dot2c_f32_bf16 v91, v75, v29
    v_dot2c_f32_bf16 v92, v76, v29
    v_dot2c_f32_bf16 v93, v77, v29
    v_dot2c_f32_bf16 v94, v78, v29
    v_dot2c_f32_bf16 v95, v79, v29
    s_waitcnt vmcnt(2)
    v_perm_b32 v64, v180, v176, s34
    v_perm_b32 v65, v180, v176, s35
    v_perm_b32 v66, v181, v177, s34
    v_perm_b32 v67, v181, v177, s35
    v_perm_b32 v68, v182, v178, s34
    v_perm_b32 v69, v182, v178, s35
    v_perm_b32 v70, v183, v179, s34
    v_perm_b32 v71, v183, v179, s35
    v_dot2c_f32_bf16 v80, v64, v22
    v_dot2c_f32_bf16 v81, v65, v22
    v_dot2c_f32_bf16 v82, v66, v22
    v_dot2c_f32_bf16 v83, v67, v22
    v_dot2c_f32_bf16 v84, v68, v22
    v_dot2c_f32_bf16 v85, v69, v22
    v_dot2c_f32_bf16 v86, v70, v22
    v_dot2c_f32_bf16 v87, v71, v22
    v_dot2c_f32_bf16 v88, v64, v30
    v_dot2c_f32_bf16 v89, v65, v30
    v_dot2c_f32_bf16 v90, v66, v30
    v_dot2c_f32_bf16 v91, v67, v30
    v_dot2c_f32_bf16 v92, v68, v30
    v_dot2c_f32_bf16 v93, v69, v30
    v_dot2c_f32_bf16 v94, v70, v30
    v_dot2c_f32_bf16 v95, v71, v30
    s_waitcnt vmcnt(0)
    v_perm_b32 v72, v188, v184, s34
    v_perm_b32 v73, v188, v184, s35
    v_perm_b32 v74, v189, v185, s34
    v_perm_b32 v75, v189, v185, s35
    v_perm_b32 v76, v190, v186, s34
    v_perm_b32 v77, v190, v186, s35
    v_perm_b32 v78, v191, v187, s34
    v_perm_b32 v79, v191, v187, s35
    v_dot2c_f32_bf16 v80, v72, v23
    v_dot2c_f32_bf16 v81, v73, v23
    v_dot2c_f32_bf16 v82, v74, v23
    v_dot2c_f32_bf16 v83, v75, v23
    v_dot2c_f32_bf16 v84, v76, v23
    v_dot2c_f32_bf16 v85, v77, v23
    v_dot2c_f32_bf16 v86, v78, v23
    v_dot2c_f32_bf16 v87, v79, v23
    v_dot2c_f32_bf16 v88, v72, v31
    v_dot2c_f32_bf16 v89, v73, v31
    v_dot2c_f32_bf16 v90, v74, v31
    v_dot2c_f32_bf16 v91, v75, v31
    v_dot2c_f32_bf16 v92, v76, v31
    v_dot2c_f32_bf16 v93, v77, v31
    v_dot2c_f32_bf16 v94, v78, v31
    v_dot2c_f32_bf16 v95, v79, v31
    v_permlane32_swap_b32 v80, v88
    v_permlane32_swap_b32 v81, v89
    v_permlane32_swap_b32 v82, v90
    v_permlane32_swap_b32 v83, v91
    v_permlane32_swap_b32 v84, v92
    v_permlane32_swap_b32 v85, v93
    v_permlane32_swap_b32 v86, v94
    v_permlane32_swap_b32 v87, v95
    v_pk_add_f32 v[80:81], v[80:81], v[88:89]
    v_pk_add_f32 v[82:83], v[82:83], v[90:91]
    v_pk_add_f32 v[84:85], v[84:85], v[92:93]
    v_pk_add_f32 v[86:87], v[86:87], v[94:95]
    s_nop 0
    v_permlane16_swap_b32 v80, v84
    v_permlane16_swap_b32 v81, v85
    v_permlane16_swap_b32 v82, v86
    v_permlane16_swap_b32 v83, v87
    v_pk_add_f32 v[80:81], v[80:81], v[84:85]
    v_pk_add_f32 v[82:83], v[82:83], v[86:87]
    s_nop 0
    v_add_f32_dpp v80, v80, v80 row_ror:8 row_mask:0xf bank_mask:0xf
    v_add_f32_dpp v81, v81, v81 row_ror:8 row_mask:0xf bank_mask:0xf
    v_add_f32_dpp v82, v82, v82 row_ror:8 row_mask:0xf bank_mask:0xf
    v_add_f32_dpp v83, v83, v83 row_ror:8 row_mask:0xf bank_mask:0xf
    s_mov_b32 exec_lo, 0x00ff00ff
    s_mov_b32 exec_hi, 0x00ff00ff
    ds_write_b128 v120, v[80:83] offset:34304
    s_mov_b64 exec, 1
    ds_add_rtn_u32 v64, v101, v121 offset:33028
    s_waitcnt lgkmcnt(0)
    v_readfirstlane_b32 s4, v64
    s_mov_b64 exec, -1
    s_cmp_lg_u32 s4, 3
    s_cbranch_scc1 L_join
    s_mov_b32 exec_hi, 0
    ds_read_b128 v[64:67], v122 offset:34304
    ds_read_b128 v[68:71], v122 offset:34816
    ds_read_b128 v[72:75], v122 offset:35328
    ds_read_b128 v[76:79], v122 offset:35840
    s_waitcnt lgkmcnt(0)
    v_pk_add_f32 v[64:65], v[64:65], v[68:69]
    v_pk_add_f32 v[72:73], v[72:73], v[76:77]
    v_pk_add_f32 v[66:67], v[66:67], v[70:71]
    v_pk_add_f32 v[74:75], v[74:75], v[78:79]
    v_pk_add_f32 v[64:65], v[64:65], v[72:73]
    v_pk_add_f32 v[66:67], v[66:67], v[74:75]
    v_cvt_pk_bf16_f32 v68, v64, v65
    v_cvt_pk_bf16_f32 v69, v66, v67
    v_lshlrev_b32 v64, 16, v68
    v_and_b32 v65, 0xffff0000, v68
    v_lshlrev_b32 v66, 16, v69
    v_and_b32 v67, 0xffff0000, v69
    v_lshlrev_b32 v68, 16, v102
    v_and_b32 v69, 0xffff0000, v102
    v_lshlrev_b32 v70, 16, v103
    v_and_b32 v71, 0xffff0000, v103
    v_pk_add_f32 v[64:65], v[64:65], v[68:69]
    v_pk_add_f32 v[66:67], v[66:67], v[70:71]
    v_cvt_pk_bf16_f32 v68, v64, v65
    v_cvt_pk_bf16_f32 v69, v66, v67
    v_lshlrev_b32 v64, 16, v68
    v_and_b32 v65, 0xffff0000, v68
    v_lshlrev_b32 v66, 16, v69
    v_and_b32 v67, 0xffff0000, v69
    s_mov_b32 s4, 0xbdd2d3e8
    v_mov_b32 v72, 0xc0135761
    v_mul_f32 v68, v64, v64
    v_mul_f32 v69, v65, v65
    v_mul_f32 v70, v66, v66
    v_mul_f32 v71, v67, v67
    v_fma_f32 v68, v68, s4, v72
    v_fma_f32 v69, v69, s4, v72
    v_fma_f32 v70, v70, s4, v72
    v_fma_f32 v71, v71, s4, v72
    v_mul_f32 v68, v68, v64
    v_mul_f32 v69, v69, v65
    v_mul_f32 v70, v70, v66
    v_mul_f32 v71, v71, v67
    v_exp_f32 v68, v68
    v_exp_f32 v69, v69
    v_exp_f32 v70, v70
    v_exp_f32 v71, v71
    v_add_f32 v68, 1.0, v68
    v_add_f32 v69, 1.0, v69
    v_add_f32 v70, 1.0, v70
    v_add_f32 v71, 1.0, v71
    v_rcp_f32 v68, v68
    v_rcp_f32 v69, v69
    v_rcp_f32 v70, v70
    v_rcp_f32 v71, v71
    v_mul_f32 v64, v64, v68
    v_mul_f32 v65, v65, v69
    v_mul_f32 v66, v66, v70
    v_mul_f32 v67, v67, v71
    v_cvt_pk_bf16_f32 v64, v64, v65
    v_cvt_pk_bf16_f32 v66, v66, v67
    v_mov_b32 v65, s36
    v_mov_b32 v67, s36
    s_movk_i32 s4, 7168
    v_mad_u32_u24 v68, v125, s4, v126
    s_lshl_b32 s4, s96, 8
    s_add_u32 s4, s4, 65536
    buffer_store_dwordx4 v[64:67], v68, s[48:51], s4 offen sc1
    s_branch L_join
L_role_g:
    s_mov_b32 s56, s88
    s_mov_b32 s57, s89
    s_mov_b32 s58, 1835008
    s_mov_b32 s59, 0x00020000
    s_and_b32 s96, s2, 7
    s_bfe_u32 s97, s2, 0x20003
    s_lshl_b32 s6, s97, 2
    s_add_u32 s6, s6, s37
    s_mul_i32 s6, s6, 112
    s_lshl_b32 s4, s6, 10
    s_lshl_b32 s5, s96, 7
    s_add_u32 s4, s4, s5
    v_mul_u32_u24 v98, 14336, v1
    v_lshl_add_u32 v98, v14, 4, v98
    buffer_load_dwordx4 v[128:131], v98, s[56:59], s4 offen offset:0 nt
    buffer_load_dwordx4 v[132:135], v98, s[56:59], s4 offen offset:1024 nt
    buffer_load_dwordx4 v[136:139], v98, s[56:59], s4 offen offset:2048 nt
    buffer_load_dwordx4 v[140:143], v98, s[56:59], s4 offen offset:3072 nt
    s_add_u32 s4, s4, 4096
    buffer_load_dwordx4 v[144:147], v98, s[56:59], s4 offen offset:0 nt
    buffer_load_dwordx4 v[148:151], v98, s[56:59], s4 offen offset:1024 nt
    buffer_load_dwordx4 v[152:155], v98, s[56:59], s4 offen offset:2048 nt
    buffer_load_dwordx4 v[156:159], v98, s[56:59], s4 offen offset:3072 nt
    s_add_u32 s4, s4, 4096
    buffer_load_dwordx4 v[160:163], v98, s[56:59], s4 offen offset:0 nt
    buffer_load_dwordx4 v[164:167], v98, s[56:59], s4 offen offset:1024 nt
    buffer_load_dwordx4 v[168:171], v98, s[56:59], s4 offen offset:2048 nt
    buffer_load_dwordx4 v[172:175], v98, s[56:59], s4 offen offset:3072 nt
    s_add_u32 s4, s4, 4096
    buffer_load_dwordx4 v[176:179], v98, s[56:59], s4 offen offset:0 nt
    buffer_load_dwordx4 v[180:183], v98, s[56:59], s4 offen offset:1024 nt
    s_waitcnt lgkmcnt(0)
    s_load_dword s39, s[48:49], 4
    v_lshrrev_b32 v120, 5, v0
    v_lshlrev_b32 v120, 8, v120
    v_bfe_u32 v123, v0, 4, 1
    v_lshl_add_u32 v120, v123, 4, v120
    v_and_b32 v123, 7, v0
    v_lshl_add_u32 v120, v123, 5, v120
    s_lshl_b32 s5, s37, 9
    v_add_u32 v120, s5, v120
    v_lshlrev_b32 v122, 4, v0
    v_mov_b32 v121, 1
    v_mov_b32 v101, 0
    v_min_u32 v99, 6, v14
    v_mad_u32_u24 v99, v1, 7, v99
    v_lshlrev_b32 v99, 3, v99
    s_lshl_b32 s6, s6, 2
    s_add_u32 s93, s6, 65536
    s_add_u32 s94, s93, 7168
    v_lshlrev_b32 v97, 5, v1
    s_waitcnt lgkmcnt(0)
    s_mul_i32 s36, s39, 0x9E3779B1
    s_add_u32 s36, s36, 0x7F4A7C15
    s_mov_b64 s[78:79], -1
    s_mov_b64 s[80:81], -1
    s_mov_b32 s92, 65536
L_hpoll_top:
    s_mov_b64 exec, s[78:79]
    s_cbranch_execz L_hpoll_s0
    buffer_load_dwordx2 v[10:11], v99, s[48:51], s93 offen sc1
L_hpoll_s0:
    s_mov_b64 exec, s[80:81]
    s_cbranch_execz L_hpoll_s1
    buffer_load_dwordx2 v[12:13], v99, s[48:51], s94 offen sc1
L_hpoll_s1:
    s_waitcnt vmcnt(0)
    s_mov_b64 exec, s[78:79]
    v_cmp_ne_u32_e64 s[78:79], v11, s36
    s_mov_b64 exec, s[80:81]
    v_cmp_ne_u32_e64 s[80:81], v13, s36
    s_mov_b64 exec, -1
    s_mov_b64 s[4:5], s[78:79]
    s_or_b64 s[4:5], s[4:5], s[80:81]
    s_cmp_eq_u64 s[4:5], 0
    s_cbranch_scc1 L_hpoll_done
    s_sleep 8
    s_sub_u32 s92, s92, 1
    s_cmp_lg_u32 s92, 0
    s_cbranch_scc1 L_hpoll_top
L_hpoll_done:
    ds_bpermute_b32 v16, v97, v10 offset:0
    ds_bpermute_b32 v17, v97, v10 offset:4
    ds_bpermute_b32 v18, v97, v10 offset:8
    ds_bpermute_b32 v19, v97, v10 offset:12
    ds_bpermute_b32 v20, v97, v10 offset:16
    ds_bpermute_b32 v21, v97, v10 offset:20
    ds_bpermute_b32 v22, v97, v10 offset:24
    ds_bpermute_b32 v24, v97, v12 offset:0
    ds_bpermute_b32 v25, v97, v12 offset:4
    ds_bpermute_b32 v26, v97, v12 offset:8
    ds_bpermute_b32 v27, v97, v12 offset:12
    ds_bpermute_b32 v28, v97, v12 offset:16
    ds_bpermute_b32 v29, v97, v12 offset:20
    ds_bpermute_b32 v30, v97, v12 offset:24
    s_waitcnt lgkmcnt(0)
    v_perm_b32 v64, v132, v128, s34
    v_perm_b32 v65, v132, v128, s35
    v_perm_b32 v66, v133, v129, s34
    v_perm_b32 v67, v133, v129, s35
    v_perm_b32 v68, v134, v130, s34
    v_perm_b32 v69, v134, v130, s35
    v_perm_b32 v70, v135, v131, s34
    v_perm_b32 v71, v135, v131, s35
    v_dot2_f32_bf16 v80, v64, v16, 0
    v_dot2_f32_bf16 v81, v65, v16, 0
    v_dot2_f32_bf16 v82, v66, v16, 0
    v_dot2_f32_bf16 v83, v67, v16, 0
    v_dot2_f32_bf16 v84, v68, v16, 0
    v_dot2_f32_bf16 v85, v69, v16, 0
    v_dot2_f32_bf16 v86, v70, v16, 0
    v_dot2_f32_bf16 v87, v71, v16, 0
    v_dot2_f32_bf16 v88, v64, v24, 0
    v_dot2_f32_bf16 v89, v65, v24, 0
    v_dot2_f32_bf16 v90, v66, v24, 0
    v_dot2_f32_bf16 v91, v67, v24, 0
    v_dot2_f32_bf16 v92, v68, v24, 0
    v_dot2_f32_bf16 v93, v69, v24, 0
    v_dot2_f32_bf16 v94, v70, v24, 0
    v_dot2_f32_bf16 v95, v71, v24, 0
    v_perm_b32 v72, v140, v136, s34
    v_perm_b32 v73, v140, v136, s35
    v_perm_b32 v74, v141, v137, s34
    v_perm_b32 v75, v141, v137, s35
    v_perm_b32 v76, v142, v138, s34
    v_perm_b32 v77, v142, v138, s35
    v_perm_b32 v78, v143, v139, s34
    v_perm_b32 v79, v143, v139, s35
    v_dot2c_f32_bf16 v80, v72, v17
    v_dot2c_f32_bf16 v81, v73, v17
    v_dot2c_f32_bf16 v82, v74, v17
    v_dot2c_f32_bf16 v83, v75, v17
    v_dot2c_f32_bf16 v84, v76, v17
    v_dot2c_f32_bf16 v85, v77, v17
    v_dot2c_f32_bf16 v86, v78, v17
    v_dot2c_f32_bf16 v87, v79, v17
    v_dot2c_f32_bf16 v88, v72, v25
    v_dot2c_f32_bf16 v89, v73, v25
    v_dot2c_f32_bf16 v90, v74, v25
    v_dot2c_f32_bf16 v91, v75, v25
    v_dot2c_f32_bf16 v92, v76, v25
    v_dot2c_f32_bf16 v93, v77, v25
    v_dot2c_f32_bf16 v94, v78, v25
    v_dot2c_f32_bf16 v95, v79, v25
    v_perm_b32 v64, v148, v144, s34
    v_perm_b32 v65, v148, v144, s35
    v_perm_b32 v66, v149, v145, s34
    v_perm_b32 v67, v149, v145, s35
    v_perm_b32 v68, v150, v146, s34
    v_perm_b32 v69, v150, v146, s35
    v_perm_b32 v70, v151, v147, s34
    v_perm_b32 v71, v151, v147, s35
    v_dot2c_f32_bf16 v80, v64, v18
    v_dot2c_f32_bf16 v81, v65, v18
    v_dot2c_f32_bf16 v82, v66, v18
    v_dot2c_f32_bf16 v83, v67, v18
    v_dot2c_f32_bf16 v84, v68, v18
    v_dot2c_f32_bf16 v85, v69, v18
    v_dot2c_f32_bf16 v86, v70, v18
    v_dot2c_f32_bf16 v87, v71, v18
    v_dot2c_f32_bf16 v88, v64, v26
    v_dot2c_f32_bf16 v89, v65, v26
    v_dot2c_f32_bf16 v90, v66, v26
    v_dot2c_f32_bf16 v91, v67, v26
    v_dot2c_f32_bf16 v92, v68, v26
    v_dot2c_f32_bf16 v93, v69, v26
    v_dot2c_f32_bf16 v94, v70, v26
    v_dot2c_f32_bf16 v95, v71, v26
    v_perm_b32 v72, v156, v152, s34
    v_perm_b32 v73, v156, v152, s35
    v_perm_b32 v74, v157, v153, s34
    v_perm_b32 v75, v157, v153, s35
    v_perm_b32 v76, v158, v154, s34
    v_perm_b32 v77, v158, v154, s35
    v_perm_b32 v78, v159, v155, s34
    v_perm_b32 v79, v159, v155, s35
    v_dot2c_f32_bf16 v80, v72, v19
    v_dot2c_f32_bf16 v81, v73, v19
    v_dot2c_f32_bf16 v82, v74, v19
    v_dot2c_f32_bf16 v83, v75, v19
    v_dot2c_f32_bf16 v84, v76, v19
    v_dot2c_f32_bf16 v85, v77, v19
    v_dot2c_f32_bf16 v86, v78, v19
    v_dot2c_f32_bf16 v87, v79, v19
    v_dot2c_f32_bf16 v88, v72, v27
    v_dot2c_f32_bf16 v89, v73, v27
    v_dot2c_f32_bf16 v90, v74, v27
    v_dot2c_f32_bf16 v91, v75, v27
    v_dot2c_f32_bf16 v92, v76, v27
    v_dot2c_f32_bf16 v93, v77, v27
    v_dot2c_f32_bf16 v94, v78, v27
    v_dot2c_f32_bf16 v95, v79, v27
    v_perm_b32 v64, v164, v160, s34
    v_perm_b32 v65, v164, v160, s35
    v_perm_b32 v66, v165, v161, s34
    v_perm_b32 v67, v165, v161, s35
    v_perm_b32 v68, v166, v162, s34
    v_perm_b32 v69, v166, v162, s35
    v_perm_b32 v70, v167, v163, s34
    v_perm_b32 v71, v167, v163, s35
    v_dot2c_f32_bf16 v80, v64, v20
    v_dot2c_f32_bf16 v81, v65, v20
    v_dot2c_f32_bf16 v82, v66, v20
    v_dot2c_f32_bf16 v83, v67, v20
    v_dot2c_f32_bf16 v84, v68, v20
    v_dot2c_f32_bf16 v85, v69, v20
    v_dot2c_f32_bf16 v86, v70, v20
    v_dot2c_f32_bf16 v87, v71, v20
    v_dot2c_f32_bf16 v88, v64, v28
    v_dot2c_f32_bf16 v89, v65, v28
    v_dot2c_f32_bf16 v90, v66, v28
    v_dot2c_f32_bf16 v91, v67, v28
    v_dot2c_f32_bf16 v92, v68, v28
    v_dot2c_f32_bf16 v93, v69, v28
    v_dot2c_f32_bf16 v94, v70, v28
    v_dot2c_f32_bf16 v95, v71, v28
    v_perm_b32 v72, v172, v168, s34
    v_perm_b32 v73, v172, v168, s35
    v_perm_b32 v74, v173, v169, s34
    v_perm_b32 v75, v173, v169, s35
    v_perm_b32 v76, v174, v170, s34
    v_perm_b32 v77, v174, v170, s35
    v_perm_b32 v78, v175, v171, s34
    v_perm_b32 v79, v175, v171, s35
    v_dot2c_f32_bf16 v80, v72, v21
    v_dot2c_f32_bf16 v81, v73, v21
    v_dot2c_f32_bf16 v82, v74, v21
    v_dot2c_f32_bf16 v83, v75, v21
    v_dot2c_f32_bf16 v84, v76, v21
    v_dot2c_f32_bf16 v85, v77, v21
    v_dot2c_f32_bf16 v86, v78, v21
    v_dot2c_f32_bf16 v87, v79, v21
    v_dot2c_f32_bf16 v88, v72, v29
    v_dot2c_f32_bf16 v89, v73, v29
    v_dot2c_f32_bf16 v90, v74, v29
    v_dot2c_f32_bf16 v91, v75, v29
    v_dot2c_f32_bf16 v92, v76, v29
    v_dot2c_f32_bf16 v93, v77, v29
    v_dot2c_f32_bf16 v94, v78, v29
    v_dot2c_f32_bf16 v95, v79, v29
    v_perm_b32 v64, v180, v176, s34
    v_perm_b32 v65, v180, v176, s35
    v_perm_b32 v66, v181, v177, s34
    v_perm_b32 v67, v181, v177, s35
    v_perm_b32 v68, v182, v178, s34
    v_perm_b32 v69, v182, v178, s35
    v_perm_b32 v70, v183, v179, s34
    v_perm_b32 v71, v183, v179, s35
    v_dot2c_f32_bf16 v80, v64, v22
    v_dot2c_f32_bf16 v81, v65, v22
    v_dot2c_f32_bf16 v82, v66, v22
    v_dot2c_f32_bf16 v83, v67, v22
    v_dot2c_f32_bf16 v84, v68, v22
    v_dot2c_f32_bf16 v85, v69, v22
    v_dot2c_f32_bf16 v86, v70, v22
    v_dot2c_f32_bf16 v87, v71, v22
    v_dot2c_f32_bf16 v88, v64, v30
    v_dot2c_f32_bf16 v89, v65, v30
    v_dot2c_f32_bf16 v90, v66, v30
    v_dot2c_f32_bf16 v91, v67, v30
    v_dot2c_f32_bf16 v92, v68, v30
    v_dot2c_f32_bf16 v93, v69, v30
    v_dot2c_f32_bf16 v94, v70, v30
    v_dot2c_f32_bf16 v95, v71, v30
    v_permlane32_swap_b32 v80, v88
    v_permlane32_swap_b32 v81, v89
    v_permlane32_swap_b32 v82, v90
    v_permlane32_swap_b32 v83, v91
    v_permlane32_swap_b32 v84, v92
    v_permlane32_swap_b32 v85, v93
    v_permlane32_swap_b32 v86, v94
    v_permlane32_swap_b32 v87, v95
    v_pk_add_f32 v[80:81], v[80:81], v[88:89]
    v_pk_add_f32 v[82:83], v[82:83], v[90:91]
    v_pk_add_f32 v[84:85], v[84:85], v[92:93]
    v_pk_add_f32 v[86:87], v[86:87], v[94:95]
    s_nop 0
    v_permlane16_swap_b32 v80, v84
    v_permlane16_swap_b32 v81, v85
    v_permlane16_swap_b32 v82, v86
    v_permlane16_swap_b32 v83, v87
    v_pk_add_f32 v[80:81], v[80:81], v[84:85]
    v_pk_add_f32 v[82:83], v[82:83], v[86:87]
    s_nop 0
    v_add_f32_dpp v80, v80, v80 row_ror:8 row_mask:0xf bank_mask:0xf
    v_add_f32_dpp v81, v81, v81 row_ror:8 row_mask:0xf bank_mask:0xf
    v_add_f32_dpp v82, v82, v82 row_ror:8 row_mask:0xf bank_mask:0xf
    v_add_f32_dpp v83, v83, v83 row_ror:8 row_mask:0xf bank_mask:0xf
    s_mov_b32 exec_lo, 0x00ff00ff
    s_mov_b32 exec_hi, 0x00ff00ff
    ds_write_b128 v120, v[80:83] offset:34304
    s_mov_b64 exec, 1
    ds_add_rtn_u32 v64, v101, v121 offset:33028
    s_waitcnt lgkmcnt(0)
    v_readfirstlane_b32 s4, v64
    s_mov_b64 exec, -1
    s_cmp_lg_u32 s4, 3
    s_cbranch_scc1 L_join
    s_mov_b32 exec_hi, 0
    ds_read_b128 v[64:67], v122 offset:34304
    ds_read_b128 v[68:71], v122 offset:34816
    ds_read_b128 v[72:75], v122 offset:35328
    ds_read_b128 v[76:79], v122 offset:35840
    s_waitcnt lgkmcnt(0)
    v_pk_add_f32 v[64:65], v[64:65], v[68:69]
    v_pk_add_f32 v[72:73], v[72:73], v[76:77]
    v_pk_add_f32 v[66:67], v[66:67], v[70:71]
    v_pk_add_f32 v[74:75], v[74:75], v[78:79]
    v_pk_add_f32 v[64:65], v[64:65], v[72:73]
    v_pk_add_f32 v[66:67], v[66:67], v[74:75]
    v_mov_b32 v68, v66
    v_mov_b32 v70, v67
    v_mov_b32 v66, v65
    v_mov_b32 v65, s36
    v_mov_b32 v67, s36
    v_mov_b32 v69, s36
    v_mov_b32 v71, s36
    v_bfe_u32 v72, v0, 2, 2
    v_lshlrev_b32 v72, 10, v72
    v_lshrrev_b32 v73, 4, v0
    v_lshl_add_u32 v72, v73, 7, v72
    v_and_b32 v73, 3, v0
    v_lshl_add_u32 v72, v73, 5, v72
    s_lshl_b32 s4, s96, 12
    s_lshl_b32 s5, s97, 8
    s_add_u32 s4, s4, s5
    s_add_u32 s4, s4, 98304
    buffer_store_dwordx4 v[64:67], v72, s[48:51], s4 offen sc1
    buffer_store_dwordx4 v[68:71], v72, s[48:51], s4 offen offset:16 sc1
    s_branch L_join
L_role_f:
    s_mov_b32 s60, s90
    s_mov_b32 s61, s91
    s_mov_b32 s62, 1024
    s_mov_b32 s63, 0x00020000
    s_and_b32 s96, s2, 31
    s_lshl_b32 s4, s96, 5
    v_lshlrev_b32 v98, 2, v14
    v_bfe_u32 v99, v0, 3, 1
    v_lshl_add_u32 v97, v99, 10, v98
    buffer_load_dword v10, v98, s[60:63], s4 offen
    buffer_load_dword v11, v97, s[52:55], s4 offen
    s_waitcnt lgkmcnt(0)
    s_load_dword s39, s[48:49], 4
    v_lshlrev_b32 v122, 4, v0
    s_lshl_b32 s93, s96, 10
    s_add_u32 s93, s93, 98304
    v_lshlrev_b32 v98, 1, v98
    v_lshl_add_u32 v98, v99, 6, v98
    v_lshrrev_b32 v99, 5, v0
    v_lshl_add_u32 v98, v99, 2, v98
    v_lshlrev_b32 v99, 4, v99
    v_sub_u32 v99, 16, v99
    s_waitcnt lgkmcnt(0)
    s_mul_i32 s36, s39, 0x9E3779B1
    s_add_u32 s36, s36, 0x7F4A7C15
    s_mov_b64 s[78:79], -1
    s_mov_b32 s92, 65536
L_gpoll_top:
    s_mov_b64 exec, s[78:79]
    s_cbranch_execz L_gpoll_s0
    buffer_load_dwordx4 v[16:19], v122, s[48:51], s93 offen sc1
L_gpoll_s0:
    s_waitcnt vmcnt(0)
    s_mov_b64 exec, s[78:79]
    v_cmp_ne_u32_e64 s[78:79], v17, s36
    v_cmp_ne_u32_e64 vcc, v19, s36
    s_or_b64 s[78:79], s[78:79], vcc
    s_mov_b64 exec, -1
    s_mov_b64 s[4:5], s[78:79]
    s_cmp_eq_u64 s[4:5], 0
    s_cbranch_scc1 L_gpoll_done
    s_sleep 16
    s_sub_u32 s92, s92, 1
    s_cmp_lg_u32 s92, 0
    s_cbranch_scc1 L_gpoll_top
L_gpoll_done:
    v_permlane32_swap_b32 v16, v18
    v_add_f32 v16, v16, v18
    v_mov_b32 v18, v16
    s_nop 1
    v_permlane16_swap_b32 v16, v18
    v_add_f32 v16, v16, v18
    v_lshlrev_b32 v10, v99, v10
    v_lshlrev_b32 v11, v99, v11
    v_and_b32 v10, 0xffff0000, v10
    v_and_b32 v11, 0xffff0000, v11
    v_cvt_pk_bf16_f32 v16, v16, v16
    v_and_b32 v16, 0xffff0000, v16
    v_add_f32 v16, v16, v10
    v_cvt_pk_bf16_f32 v16, v16, v16
    v_and_b32 v16, 0xffff0000, v16
    v_mul_f32 v18, 0xbfb8aa3b, v16
    v_exp_f32 v18, v18
    s_nop 0
    v_add_f32 v18, 1.0, v18
    v_rcp_f32 v18, v18
    s_nop 0
    v_mul_f32 v16, v16, v18
    v_cvt_pk_bf16_f32 v16, v16, v16
    v_and_b32 v16, 0xffff0000, v16
    ds_write_b32 v98, v16 offset:36352
    ds_write_b32 v98, v11 offset:36480
    s_branch L_join
L_tail:
    s_setprio 3
    v_and_b32 v12, 3, v0
    v_lshlrev_b32 v12, 9, v12
    v_lshrrev_b32 v9, 4, v0
    v_lshl_add_u32 v12, v9, 4, v12
    v_bfe_u32 v3, v0, 2, 2
    v_lshl_add_u32 v12, v3, 2, v12
    s_lshl_b32 s4, s37, 6
    v_add_u32 v12, s4, v12
    s_lshl_b32 s4, s37, 5
    v_mov_b32 v3, s4
    v_lshlrev_b32 v122, 4, v0
    v_mov_b32 v101, 0
    v_lshrrev_b32 v13, 5, v0
    v_and_b32 v7, 31, v0
    v_lshlrev_b32 v4, 4, v7
    v_lshl_add_u32 v4, v13, 12, v4
    v_and_b32 v8, 15, v0
    v_add3_u32 v14, v8, v13, s38
    v_and_b32 v14, 15, v14
    v_lshlrev_b32 v14, 4, v14
    v_lshl_add_u32 v15, v7, 1, v13
    v_lshlrev_b32 v15, 2, v15
    s_lshl_b32 s4, s37, 8
    v_add_u32 v15, s4, v15
    v_and_b32 v7, 1, v0
    v_lshlrev_b32 v7, 9, v7
    v_lshl_add_u32 v7, v9, 5, v7
    v_lshlrev_b32 v10, 15, v9
    v_lshl_add_u32 v10, v8, 4, v10
    v_lshl_add_u32 v11, v13, 4, v8
    v_lshlrev_b32 v11, 2, v11
    s_lshl_b32 s4, s37, 7
    v_add_u32 v11, s4, v11
    s_waitcnt lgkmcnt(0)
    s_mul_i32 s36, s39, 0x9E3779B1
    s_add_u32 s36, s36, 0x7F4A7C15
    v_mov_b32 v65, s36
    v_mov_b32 v67, s36
    v_mov_b32 v69, s36
    v_mov_b32 v71, s36
    s_barrier
    ds_read_b128 v[16:19], v3 offset:32768
    ds_read_b128 v[20:23], v3 offset:32784
    ds_read_b128 v[24:27], v3 offset:32896
    ds_read_b128 v[28:31], v3 offset:32912
    ds_read2st64_b32 v[32:33], v12 offset0:0 offset1:1
    ds_read2st64_b32 v[34:35], v12 offset0:8 offset1:9
    ds_read2st64_b32 v[36:37], v12 offset0:16 offset1:17
    ds_read2st64_b32 v[38:39], v12 offset0:24 offset1:25
    ds_read2st64_b32 v[40:41], v12 offset0:32 offset1:33
    ds_read2st64_b32 v[42:43], v12 offset0:40 offset1:41
    ds_read2st64_b32 v[44:45], v12 offset0:48 offset1:49
    ds_read2st64_b32 v[46:47], v12 offset0:56 offset1:57
    s_waitcnt lgkmcnt(10)
    v_max3_f32 v68, v16, v17, v18
    v_max3_f32 v70, v19, v20, v21
    v_max3_f32 v68, v68, v22, v23
    v_max_f32 v68, v68, v70
    v_sub_f32 v16, v16, v68
    v_sub_f32 v17, v17, v68
    v_sub_f32 v18, v18, v68
    v_sub_f32 v19, v19, v68
    v_sub_f32 v20, v20, v68
    v_sub_f32 v21, v21, v68
    v_sub_f32 v22, v22, v68
    v_sub_f32 v23, v23, v68
    v_exp_f32 v16, v16
    v_exp_f32 v17, v17
    v_exp_f32 v18, v18
    v_exp_f32 v19, v19
    v_exp_f32 v20, v20
    v_exp_f32 v21, v21
    v_exp_f32 v22, v22
    v_exp_f32 v23, v23
    s_waitcnt lgkmcnt(0)
    v_mul_f32 v64, v16, v32
    v_mul_f32 v66, v16, v33
    v_mul_f32 v70, v16, v24
    v_fmac_f32 v64, v17, v34
    v_fmac_f32 v66, v17, v35
    v_fmac_f32 v70, v17, v25
    v_fmac_f32 v64, v18, v36
    v_fmac_f32 v66, v18, v37
    v_fmac_f32 v70, v18, v26
    v_fmac_f32 v64, v19, v38
    v_fmac_f32 v66, v19, v39
    v_fmac_f32 v70, v19, v27
    v_fmac_f32 v64, v20, v40
    v_fmac_f32 v66, v20, v41
    v_fmac_f32 v70, v20, v28
    v_fmac_f32 v64, v21, v42
    v_fmac_f32 v66, v21, v43
    v_fmac_f32 v70, v21, v29
    v_fmac_f32 v64, v22, v44
    v_fmac_f32 v66, v22, v45
    v_fmac_f32 v70, v22, v30
    v_fmac_f32 v64, v23, v46
    v_fmac_f32 v66, v23, v47
    v_fmac_f32 v70, v23, v31
    buffer_store_dwordx4 v[64:67], v122, s[48:51], s72 offen sc1
    s_mov_b64 exec, 1
    buffer_store_dwordx4 v[68:71], v101, s[48:51], s73 offen sc1
    s_mov_b64 exec, -1
    s_cmp_lg_u32 s37, 3
    s_cbranch_scc1 L_wo_skip
    ds_read_b128 v[192:195], v122 offset:16384
    ds_read_b128 v[196:199], v122 offset:17408
    ds_read_b128 v[200:203], v122 offset:18432
    ds_read_b128 v[204:207], v122 offset:19456
    ds_read_b128 v[208:211], v122 offset:20480
    ds_read_b128 v[212:215], v122 offset:21504
    ds_read_b128 v[216:219], v122 offset:22528
    ds_read_b128 v[220:223], v122 offset:23552
    s_waitcnt lgkmcnt(4)
    ds_read_b128 v[224:227], v122 offset:24576
    ds_read_b128 v[228:231], v122 offset:25600
    ds_read_b128 v[232:235], v122 offset:26624
    ds_read_b128 v[236:239], v122 offset:27648
    ds_read_b128 v[240:243], v122 offset:28672
    ds_read_b128 v[244:247], v122 offset:29696
    ds_read_b128 v[248:251], v122 offset:30720
    ds_read_b128 v[252:255], v122 offset:31744
L_wo_skip:
    s_mov_b64 s[78:79], -1
    s_mov_b64 s[80:81], -1
    s_mov_b64 s[82:83], -1
    s_mov_b64 s[84:85], -1
    s_mov_b64 s[86:87], -1
    s_mov_b32 s92, 65536
L_ppoll_top:
    s_mov_b64 exec, s[78:79]
    s_cbranch_execz L_ppoll_s0
    buffer_load_dwordx4 v[16:19], v14, s[48:51], s74 offen sc1
L_ppoll_s0:
    s_mov_b64 exec, s[80:81]
    s_cbranch_execz L_ppoll_s1
    buffer_load_dwordx4 v[20:23], v4, s[48:51], s98 offen sc1
L_ppoll_s1:
    s_mov_b64 exec, s[82:83]
    s_cbranch_execz L_ppoll_s2
    buffer_load_dwordx4 v[24:27], v4, s[48:51], s99 offen sc1
L_ppoll_s2:
    s_mov_b64 exec, s[84:85]
    s_cbranch_execz L_ppoll_s3
    buffer_load_dwordx4 v[28:31], v4, s[48:51], s100 offen sc1
L_ppoll_s3:
    s_mov_b64 exec, s[86:87]
    s_cbranch_execz L_ppoll_s4
    buffer_load_dwordx4 v[32:35], v4, s[48:51], s101 offen sc1
L_ppoll_s4:
    s_waitcnt vmcnt(0)
    s_mov_b64 exec, s[78:79]
    v_cmp_ne_u32_e64 s[78:79], v17, s36
    v_cmp_ne_u32_e64 vcc, v19, s36
    s_or_b64 s[78:79], s[78:79], vcc
    s_mov_b64 exec, s[80:81]
    v_cmp_ne_u32_e64 s[80:81], v21, s36
    v_cmp_ne_u32_e64 vcc, v23, s36
    s_or_b64 s[80:81], s[80:81], vcc
    s_mov_b64 exec, s[82:83]
    v_cmp_ne_u32_e64 s[82:83], v25, s36
    v_cmp_ne_u32_e64 vcc, v27, s36
    s_or_b64 s[82:83], s[82:83], vcc
    s_mov_b64 exec, s[84:85]
    v_cmp_ne_u32_e64 s[84:85], v29, s36
    v_cmp_ne_u32_e64 vcc, v31, s36
    s_or_b64 s[84:85], s[84:85], vcc
    s_mov_b64 exec, s[86:87]
    v_cmp_ne_u32_e64 s[86:87], v33, s36
    v_cmp_ne_u32_e64 vcc, v35, s36
    s_or_b64 s[86:87], s[86:87], vcc
    s_mov_b64 exec, -1
    s_mov_b64 s[4:5], s[78:79]
    s_or_b64 s[4:5], s[4:5], s[80:81]
    s_or_b64 s[4:5], s[4:5], s[82:83]
    s_or_b64 s[4:5], s[4:5], s[84:85]
    s_or_b64 s[4:5], s[4:5], s[86:87]
    s_cmp_eq_u64 s[4:5], 0
    s_cbranch_scc1 L_ppoll_done
    s_sleep 1
    s_sub_u32 s92, s92, 1
    s_cmp_lg_u32 s92, 0
    s_cbranch_scc1 L_ppoll_top
L_ppoll_done:
    v_mov_b32 v17, v16
    s_nop 1
    v_max_f32_dpp v17, v17, v17 row_ror:8 row_mask:0xf bank_mask:0xf
    s_nop 1
    v_max_f32_dpp v17, v17, v17 row_ror:4 row_mask:0xf bank_mask:0xf
    s_nop 1
    v_max_f32_dpp v17, v17, v17 row_ror:2 row_mask:0xf bank_mask:0xf
    s_nop 1
    v_max_f32_dpp v17, v17, v17 row_ror:1 row_mask:0xf bank_mask:0xf
    v_sub_f32 v16, v16, v17
    v_exp_f32 v16, v16
    s_nop 0
    v_mul_f32 v18, v16, v18
    s_nop 1
    v_add_f32_dpp v18, v18, v18 row_ror:8 row_mask:0xf bank_mask:0xf
    s_nop 1
    v_add_f32_dpp v18, v18, v18 row_ror:4 row_mask:0xf bank_mask:0xf
    s_nop 1
    v_add_f32_dpp v18, v18, v18 row_ror:2 row_mask:0xf bank_mask:0xf
    s_nop 1
    v_add_f32_dpp v18, v18, v18 row_ror:1 row_mask:0xf bank_mask:0xf
    v_rcp_f32 v18, v18
    s_nop 0
    v_mul_f32 v16, v16, v18
    s_nop 1
    v_mul_f32_dpp v36, v16, v20 row_newbcast:0 row_mask:0xf bank_mask:0xf
    v_mul_f32_dpp v37, v16, v22 row_newbcast:0 row_mask:0xf bank_mask:0xf
    s_nop 0
    v_fmac_f32_dpp v36, v16, v24 row_newbcast:2 row_mask:0xf bank_mask:0xf
    v_fmac_f32_dpp v37, v16, v26 row_newbcast:2 row_mask:0xf bank_mask:0xf
    s_nop 0
    v_fmac_f32_dpp v36, v16, v28 row_newbcast:4 row_mask:0xf bank_mask:0xf
    v_fmac_f32_dpp v37, v16, v30 row_newbcast:4 row_mask:0xf bank_mask:0xf
    s_nop 0
    v_fmac_f32_dpp v36, v16, v32 row_newbcast:6 row_mask:0xf bank_mask:0xf
    v_fmac_f32_dpp v37, v16, v34 row_newbcast:6 row_mask:0xf bank_mask:0xf
    s_nop 1
    v_permlane32_swap_b32 v36, v37
    v_add_f32 v36, v36, v37
    ds_write_b32 v15, v36 offset:36608
    s_waitcnt lgkmcnt(0)
    s_barrier
    s_cmp_lg_u32 s37, 3
    s_cbranch_scc1 L_h6_skip
    ds_read_b128 v[32:35], v7 offset:36608
    ds_read_b128 v[36:39], v7 offset:36624
    ds_read_b128 v[40:43], v7 offset:36864
    ds_read_b128 v[44:47], v7 offset:36880
    ds_read_b128 v[48:51], v7 offset:36736
    ds_read_b128 v[52:55], v7 offset:36752
    ds_read_b128 v[56:59], v7 offset:36992
    ds_read_b128 v[60:63], v7 offset:37008
    s_mov_b32 s78, 0xcccccccc
    s_mov_b32 s79, 0xcccccccc
    s_mov_b32 s80, 0xf0f0f0f0
    s_mov_b32 s81, 0xf0f0f0f0
    s_mov_b32 s82, 0xff00ff00
    s_mov_b32 s83, 0xff00ff00
    s_waitcnt lgkmcnt(0)
    v_pk_add_f32 v[32:33], v[32:33], v[40:41]
    v_pk_add_f32 v[34:35], v[34:35], v[42:43]
    v_pk_add_f32 v[36:37], v[36:37], v[44:45]
    v_pk_add_f32 v[38:39], v[38:39], v[46:47]
    v_pk_add_f32 v[48:49], v[48:49], v[56:57]
    v_pk_add_f32 v[50:51], v[50:51], v[58:59]
    v_pk_add_f32 v[52:53], v[52:53], v[60:61]
    v_pk_add_f32 v[54:55], v[54:55], v[62:63]
    v_cvt_pk_bf16_f32 v16, v32, v33
    v_cvt_pk_bf16_f32 v17, v34, v35
    v_cvt_pk_bf16_f32 v18, v36, v37
    v_cvt_pk_bf16_f32 v19, v38, v39
    v_cvt_pk_bf16_f32 v20, v48, v49
    v_cvt_pk_bf16_f32 v21, v50, v51
    v_cvt_pk_bf16_f32 v22, v52, v53
    v_cvt_pk_bf16_f32 v23, v54, v55
    v_mfma_f32_16x16x32_bf16 v[128:131], v[192:195], v[16:19], 0
    v_mfma_f32_16x16x32_bf16 v[132:135], v[196:199], v[16:19], 0
    v_mfma_f32_16x16x32_bf16 v[136:139], v[200:203], v[16:19], 0
    v_mfma_f32_16x16x32_bf16 v[140:143], v[204:207], v[16:19], 0
    v_mfma_f32_16x16x32_bf16 v[144:147], v[208:211], v[16:19], 0
    v_mfma_f32_16x16x32_bf16 v[148:151], v[212:215], v[16:19], 0
    v_mfma_f32_16x16x32_bf16 v[152:155], v[216:219], v[16:19], 0
    v_mfma_f32_16x16x32_bf16 v[156:159], v[220:223], v[16:19], 0
    v_mfma_f32_16x16x32_bf16 v[128:131], v[224:227], v[20:23], v[128:131]
    v_mfma_f32_16x16x32_bf16 v[132:135], v[228:231], v[20:23], v[132:135]
    v_mfma_f32_16x16x32_bf16 v[136:139], v[232:235], v[20:23], v[136:139]
    v_mfma_f32_16x16x32_bf16 v[140:143], v[236:239], v[20:23], v[140:143]
    v_mfma_f32_16x16x32_bf16 v[144:147], v[240:243], v[20:23], v[144:147]
    v_mfma_f32_16x16x32_bf16 v[148:151], v[244:247], v[20:23], v[148:151]
    v_mfma_f32_16x16x32_bf16 v[152:155], v[248:251], v[20:23], v[152:155]
    v_mfma_f32_16x16x32_bf16 v[156:159], v[252:255], v[20:23], v[156:159]
    s_nop 1
    v_cndmask_b32_e64 v160, v128, v132, s[78:79]
    v_cndmask_b32_e64 v161, v129, v133, s[78:79]
    v_cndmask_b32_e64 v162, v130, v134, s[78:79]
    v_cndmask_b32_e64 v163, v131, v135, s[78:79]
    v_cndmask_b32_e64 v164, v136, v140, s[78:79]
    v_cndmask_b32_e64 v165, v137, v141, s[78:79]
    v_cndmask_b32_e64 v166, v138, v142, s[78:79]
    v_cndmask_b32_e64 v167, v139, v143, s[78:79]
    v_cndmask_b32_e64 v168, v144, v148, s[78:79]
    v_cndmask_b32_e64 v169, v145, v149, s[78:79]
    v_cndmask_b32_e64 v170, v146, v150, s[78:79]
    v_cndmask_b32_e64 v171, v147, v151, s[78:79]
    v_cndmask_b32_e64 v172, v152, v156, s[78:79]
    v_cndmask_b32_e64 v173, v153, v157, s[78:79]
    v_cndmask_b32_e64 v174, v154, v158, s[78:79]
    v_cndmask_b32_e64 v175, v155, v159, s[78:79]
    v_cndmask_b32_e64 v176, v160, v164, s[80:81]
    v_cndmask_b32_e64 v177, v161, v165, s[80:81]
    v_cndmask_b32_e64 v178, v162, v166, s[80:81]
    v_cndmask_b32_e64 v179, v163, v167, s[80:81]
    v_cndmask_b32_e64 v180, v168, v172, s[80:81]
    v_cndmask_b32_e64 v181, v169, v173, s[80:81]
    v_cndmask_b32_e64 v182, v170, v174, s[80:81]
    v_cndmask_b32_e64 v183, v171, v175, s[80:81]
    v_cndmask_b32_e64 v64, v176, v180, s[82:83]
    v_cndmask_b32_e64 v66, v177, v181, s[82:83]
    v_cndmask_b32_e64 v68, v178, v182, s[82:83]
    v_cndmask_b32_e64 v70, v179, v183, s[82:83]
    buffer_store_dwordx4 v[64:67], v10, s[48:51], s75 offen sc1
    buffer_store_dwordx4 v[68:71], v10, s[48:51], s76 offen sc1
L_h6_skip:
    s_lshr_b32 s4, s2, 5
    s_cmp_lg_u32 s4, 4
    s_cbranch_scc1 L_h_exit
    v_bfe_u32 v16, v0, 1, 3
    v_bfe_u32 v17, v0, 4, 1
    v_lshl_add_u32 v16, v17, 3, v16
    v_and_b32 v17, 1, v0
    v_lshlrev_b32 v118, 2, v16
    v_lshl_add_u32 v118, v17, 6, v118
    v_lshlrev_b32 v119, 1, v16
    v_lshl_add_u32 v119, v17, 10, v119
    ds_read_b32 v116, v118 offset:36352
    ds_read_b32 v117, v118 offset:36480
    s_mov_b64 s[78:79], -1
    s_mov_b64 s[80:81], -1
    s_mov_b64 s[82:83], -1
    s_mov_b64 s[84:85], -1
    s_mov_b32 s92, 65536
L_spoll_top:
    s_mov_b64 exec, s[78:79]
    s_cbranch_execz L_spoll_s0
    buffer_load_dwordx4 v[20:23], v122, s[48:51], s77 offen offset:0 sc1
L_spoll_s0:
    s_mov_b64 exec, s[80:81]
    s_cbranch_execz L_spoll_s1
    buffer_load_dwordx4 v[24:27], v122, s[48:51], s77 offen offset:1024 sc1
L_spoll_s1:
    s_mov_b64 exec, s[82:83]
    s_cbranch_execz L_spoll_s2
    buffer_load_dwordx4 v[28:31], v122, s[48:51], s77 offen offset:2048 sc1
L_spoll_s2:
    s_mov_b64 exec, s[84:85]
    s_cbranch_execz L_spoll_s3
    buffer_load_dwordx4 v[32:35], v122, s[48:51], s77 offen offset:3072 sc1
L_spoll_s3:
    s_waitcnt vmcnt(0)
    s_mov_b64 exec, s[78:79]
    v_cmp_ne_u32_e64 s[78:79], v21, s36
    v_cmp_ne_u32_e64 vcc, v23, s36
    s_or_b64 s[78:79], s[78:79], vcc
    s_mov_b64 exec, s[80:81]
    v_cmp_ne_u32_e64 s[80:81], v25, s36
    v_cmp_ne_u32_e64 vcc, v27, s36
    s_or_b64 s[80:81], s[80:81], vcc
    s_mov_b64 exec, s[82:83]
    v_cmp_ne_u32_e64 s[82:83], v29, s36
    v_cmp_ne_u32_e64 vcc, v31, s36
    s_or_b64 s[82:83], s[82:83], vcc
    s_mov_b64 exec, s[84:85]
    v_cmp_ne_u32_e64 s[84:85], v33, s36
    v_cmp_ne_u32_e64 vcc, v35, s36
    s_or_b64 s[84:85], s[84:85], vcc
    s_mov_b64 exec, -1
    s_mov_b64 s[4:5], s[78:79]
    s_or_b64 s[4:5], s[4:5], s[80:81]
    s_or_b64 s[4:5], s[4:5], s[82:83]
    s_or_b64 s[4:5], s[4:5], s[84:85]
    s_cmp_eq_u64 s[4:5], 0
    s_cbranch_scc1 L_spoll_done
    s_sleep 1
    s_sub_u32 s92, s92, 1
    s_cmp_lg_u32 s92, 0
    s_cbranch_scc1 L_spoll_top
L_spoll_done:
    v_add_f32 v20, v20, v24
    v_add_f32 v22, v22, v26
    v_add_f32 v28, v28, v32
    v_add_f32 v30, v30, v34
    v_add_f32 v20, v20, v28
    v_add_f32 v22, v22, v30
    s_nop 1
    v_permlane32_swap_b32 v20, v22
    v_add_f32 v20, v20, v22
    v_mov_b32 v22, v20
    s_nop 1
    v_permlane16_swap_b32 v20, v22
    v_add_f32 v20, v20, v22
    ds_write_b32 v11, v20 offset:37632
    s_waitcnt lgkmcnt(0)
    s_barrier
    s_cmp_lg_u32 s37, 0
    s_cbranch_scc1 L_h_exit
    s_mov_b32 exec_hi, 0
    v_lshlrev_b32 v16, 2, v0
    v_add_u32 v16, 37632, v16
    ds_read2_b32 v[20:21], v16 offset0:0 offset1:32
    ds_read2_b32 v[22:23], v16 offset0:64 offset1:96
    s_waitcnt lgkmcnt(0)
    v_pk_add_f32 v[20:21], v[20:21], v[22:23]
    v_add_f32 v20, v20, v21
    v_cvt_pk_bf16_f32 v20, v20, v20
    v_and_b32 v20, 0xffff0000, v20
    v_mul_f32 v20, v20, v116
    v_cvt_pk_bf16_f32 v20, v20, v20
    v_and_b32 v20, 0xffff0000, v20
    v_add_f32 v20, v20, v117
    v_cvt_pk_bf16_f32 v20, v20, v20
    buffer_store_short v20, v119, s[68:71], s95 offen
    s_cmp_lg_u32 s2, 128
    s_cbranch_scc1 L_h_exit
    s_mov_b64 exec, 1
    buffer_store_dword v65, v101, s[48:51], 0 offen offset:4
L_h_exit:
L_end:
    s_endpgm
.section .rodata,"a"
.p2align 6
.amdhsa_kernel recurrent_scan__gqa_block_cached__mixer_channel_mlp__decode_kernel
  .amdhsa_next_free_vgpr 256
  .amdhsa_next_free_sgpr 102
  .amdhsa_accum_offset 256
  .amdhsa_group_segment_fixed_size 0
  .amdhsa_kernarg_size 104
  .amdhsa_user_sgpr_count 2
  .amdhsa_user_sgpr_kernarg_segment_ptr 1
  .amdhsa_system_sgpr_workgroup_id_x 1
.end_amdhsa_kernel
```
